```python
import torch

def _softmax(x, axis=-1):
    return torch.softmax(x, dim=axis)
def _gelu(x):
    return torch.nn.functional.gelu(x, approximate="tanh")
def _silu(x):
    return torch.nn.functional.silu(x)
def _sigmoid(x):
    return torch.sigmoid(x)
def _layernorm(x, axis=-1, eps=1e-5):
    m = x.mean(dim=axis, keepdim=True)
    v = x.var(dim=axis, keepdim=True, unbiased=False)
    return (x - m) / torch.sqrt(v + eps)
def _scatter_add(tgt, idx, src, axis=0):
    return tgt.clone().index_add_(axis, idx, src)
def _segment_sum(src, seg, n):
    out = torch.zeros((n,) + src.shape[1:], dtype=src.dtype)
    return out.index_add_(0, seg, src)
def _pad(x, pw):
    flat = tuple(v for pair in reversed(pw) for v in pair)
    return torch.nn.functional.pad(x, flat)

kernel_name = 'recurrent_scan__ssm_conv_s4d__geglu_ffn__prompt'

def setup_inputs():

    _w = (lambda a: (lambda t: t.to(torch.bfloat16) if t.is_floating_point() else t)(torch.as_tensor(a)))
    def _A_setup():
        Bsz, L, D, N = 1, 2048, 512, 128
        return {
            "u": _w((lambda *s: torch.randn(*s, dtype=torch.bfloat16) * 0.05)(Bsz, L, D)),
            "log_A_real": _w((lambda *s: torch.randn(*s, dtype=torch.bfloat16) * 6.4)(D, N) * 0.5),
            "A_imag": _w((lambda *s: torch.randn(*s, dtype=torch.bfloat16) * 0.05)(D, N) * 3.14),
            "C_real": _w((lambda *s: torch.randn(*s, dtype=torch.bfloat16) * 0.05)(D, N) / N ** 0.5),
            "C_imag": _w((lambda *s: torch.randn(*s, dtype=torch.bfloat16) * 0.05)(D, N) / N ** 0.5),
            "log_dt": _w((lambda *s: torch.randn(*s, dtype=torch.bfloat16) * 0.05)(D) * 0.5 - 4.0),
            "D_skip": _w((lambda *s: torch.randn(*s, dtype=torch.bfloat16) * 0.05)(D)),
        }
    _A_in = _A_setup()

    def _B_setup():
        B, S, D, F = 1, 2048, 512, 1792
        return {
            "x": _w((lambda *s: torch.randn(*s, dtype=torch.bfloat16) * 0.05)(B, S, D)),
            "w_gate": _w((lambda *s: torch.randn(*s, dtype=torch.bfloat16) * 0.05)(D, F)),
            "w_up": _w((lambda *s: torch.randn(*s, dtype=torch.bfloat16) * 0.05)(D, F)),
            "w_down": _w((lambda *s: torch.randn(*s, dtype=torch.bfloat16) * 0.05)(F, D)),
        }
    _B_in = _B_setup()

    return {
        "A_u": _A_in["u"],
        "A_log_A_real": _A_in["log_A_real"],
        "A_A_imag": _A_in["A_imag"],
        "A_C_real": _A_in["C_real"],
        "A_C_imag": _A_in["C_imag"],
        "A_log_dt": _A_in["log_dt"],
        "A_D_skip": _A_in["D_skip"],
        "B_x": _B_in["x"],
        "B_w_gate": _B_in["w_gate"],
        "B_w_up": _B_in["w_up"],
        "B_w_down": _B_in["w_down"],
    }

def reference(A_u, A_log_A_real, A_A_imag, A_C_real, A_C_imag, A_log_dt, A_D_skip, B_x, B_w_gate, B_w_up, B_w_down):
    def _A_ref(u, log_A_real, A_imag, C_real, C_imag, log_dt, D_skip):
        L = u.shape[1]
        dt = torch.exp(log_dt)
        A = -torch.exp(log_A_real) + 1j * A_imag
        C = (C_real + 1j * C_imag) * dt[:, None]
        pos = (lambda x, dt: x.to(dt))(torch.arange(L), log_dt.dtype)
        P = torch.exp((A * dt[:, None])[:, :, None] * pos[None, None, :])
        K = 2.0 * torch.einsum("dn,dnl->dl", C, P).real
        L2 = 2 * L
        u_t = (lambda x, *d: x.permute(*d))(u, 0, 2, 1)
        Kf = (lambda x, *a, **k: torch.fft.rfft(x.float(), *a, **k))(K, L2)
        Uf = (lambda x, *a, **k: torch.fft.rfft(x.float(), *a, **k))(u_t, L2)
        y = (lambda x, *a, **k: torch.fft.irfft(x, *a, **k).to(torch.bfloat16))(Uf * Kf[None, :, :], L2)[:, :, :L]
        y = (lambda x, *d: x.permute(*d))(y, 0, 2, 1)
        return y + u * D_skip[None, None, :]

    def _B_ref(x, w_gate, w_up, w_down):
        return (_gelu(x @ w_gate) * (x @ w_up)) @ w_down

    x = A_u
    xn = _layernorm(x, axis=-1)
    s = _A_ref(xn, A_log_A_real, A_A_imag, A_C_real, A_C_imag, A_log_dt, A_D_skip)
    g = _silu(_B_ref(xn, B_w_gate, B_w_up, B_w_down))
    return x + s * g
```

```asm
; @launch kernel=k1_kernel grid=(800,1,1) block=(256,1,1) lds=20480
; @launch kernel=k2_kernel grid=(512,1,1) block=(256,1,1) lds=73728
; @launch kernel=k3_kernel grid=(256,1,1) block=(256,1,1) lds=131072
.amdgcn_target "amdgcn-amd-amdhsa--gfx950"
.text
.globl k1_kernel
.p2align 8
.type k1_kernel,@function
k1_kernel:
    s_cmp_ge_u32 s2, 800
    s_cbranch_scc1 k1_end
    s_load_dwordx2 s[14:15], s[0:1], 104
    v_lshrrev_b32 v1, 6, v0
    v_and_b32 v2, 63, v0
    v_readfirstlane_b32 s3, v1
    s_cmp_lt_u32 s2, 64
    s_cbranch_scc1 k1_ln
    s_cmp_lt_u32 s2, 576
    s_cbranch_scc1 k1_kgen
    s_branch k1_shg
k1_kgen:
    s_mov_b32 s97, s2
    s_sub_u32 s2, s2, 64
    s_load_dwordx8 s[4:11], s[0:1], 8
    s_load_dwordx2 s[12:13], s[0:1], 40
    v_and_b32 v3, 31, v2
    s_lshl_b32 s84, s2, 8
    s_lshl_b32 s85, s3, 6
    s_add_u32 s84, s84, s85
    v_lshlrev_b32 v9, 1, v3
    v_add_u32 v9, s84, v9
    s_waitcnt lgkmcnt(0)
    s_mov_b32 s80, s14
    s_and_b32 s81, s15, 0xffff
    s_mov_b32 s82, 0x01b00000
    s_mov_b32 s83, 0x00020000
    s_mov_b32 s16, s4
    s_and_b32 s17, s5, 0xffff
    s_mov_b32 s18, 131072
    s_mov_b32 s19, 0x00020000
    s_mov_b32 s20, s6
    s_and_b32 s21, s7, 0xffff
    s_mov_b32 s22, 131072
    s_mov_b32 s23, 0x00020000
    s_mov_b32 s24, s8
    s_and_b32 s25, s9, 0xffff
    s_mov_b32 s26, 131072
    s_mov_b32 s27, 0x00020000
    s_mov_b32 s28, s10
    s_and_b32 s29, s11, 0xffff
    s_mov_b32 s30, 131072
    s_mov_b32 s31, 0x00020000
    s_lshr_b32 s85, s2, 1
    s_lshl_b32 s85, s85, 2
    s_add_u32 s12, s12, s85
    s_addc_u32 s13, s13, 0
    s_load_dword s86, s[12:13], 0
    buffer_load_ushort v10, v9, s[16:19], 0 offen
    buffer_load_ushort v11, v9, s[20:23], 0 offen
    buffer_load_ushort v12, v9, s[24:27], 0 offen
    buffer_load_ushort v13, v9, s[28:31], 0 offen
    s_mov_b32 s88, 0x3fb8aa3b
    s_mov_b32 s89, 0x32a57060
    s_mov_b32 s90, 0x3e22f983
    s_mov_b32 s91, 0x31dc9c88
    v_lshlrev_b32 v20, 1, v3
    v_add_u32 v20, 240, v20
    v_subrev_u32 v21, 12, v3
    v_lshrrev_b32 v22, 1, v21
    v_lshlrev_b32 v22, 8, v22
    v_and_b32 v21, 1, v21
    v_lshlrev_b32 v21, 2, v21
    v_add_u32 v21, v21, v22
    v_add_u32 v21, 512, v21
    v_subrev_u32 v22, 12, v3
    v_lshlrev_b32 v22, 8, v22
    v_mov_b32 v23, 0
    v_mov_b32 v5, v3
    v_cmp_le_u32 vcc, 8, v3
    s_nop 1
    v_cndmask_b32 v5, v5, v20, vcc
    v_cmp_le_u32 vcc, 12, v3
    s_nop 1
    v_cndmask_b32 v5, v5, v21, vcc
    v_cmp_le_u32 vcc, 16, v3
    s_nop 1
    v_cndmask_b32 v5, v5, v22, vcc
    v_cmp_le_u32 vcc, 21, v3
    s_nop 1
    v_cndmask_b32 v5, v5, v23, vcc
    v_cvt_f32_u32 v5, v5
    v_lshlrev_b32 v6, 3, v3
    v_cvt_f32_u32 v6, v6
    s_mul_i32 s87, s3, 640
    s_add_u32 s87, s87, 16384
    v_lshlrev_b32 v4, 2, v3
    v_add_u32 v4, s87, v4
    v_lshrrev_b32 v9, 5, v2
    v_lshlrev_b32 v9, 4, v9
    v_add_u32 v9, s87, v9
    v_mov_b32 v80, 0
    v_mov_b32 v81, 0
    v_mov_b32 v82, 0
    v_mov_b32 v83, 0
    v_mov_b32 v84, 0
    v_mov_b32 v85, 0
    v_mov_b32 v86, 0
    v_mov_b32 v87, 0
    v_mov_b32 v88, 0
    v_mov_b32 v89, 0
    v_mov_b32 v90, 0
    v_mov_b32 v91, 0
    v_mov_b32 v92, 0
    v_mov_b32 v93, 0
    v_mov_b32 v94, 0
    v_mov_b32 v95, 0
    s_waitcnt lgkmcnt(0)
    s_lshr_b32 s87, s86, 16
    s_and_b32 s86, s86, 0xffff
    s_bitcmp1_b32 s2, 0
    s_cselect_b32 s86, s87, s86
    s_lshl_b32 s86, s86, 16
    v_mov_b32 v24, s86
    v_mul_f32 v14, s88, v24
    v_fma_f32 v15, v24, s88, -v14
    v_fma_f32 v15, v24, s89, v15
    v_exp_f32 v16, v14
    v_mul_f32 v15, 0x3f317218, v15
    s_nop 0
    v_fma_f32 v16, v16, v15, v16
    v_cvt_pk_bf16_f32 v16, v16, v16
    v_lshlrev_b32 v7, 16, v16
    v_add_f32 v8, v7, v7
    s_waitcnt vmcnt(0)
    v_lshlrev_b32 v10, 16, v10
    v_lshlrev_b32 v11, 16, v11
    v_lshlrev_b32 v12, 16, v12
    v_lshlrev_b32 v13, 16, v13
    v_mul_f32 v14, s88, v10
    v_fma_f32 v15, v10, s88, -v14
    v_fma_f32 v15, v10, s89, v15
    v_exp_f32 v16, v14
    v_mul_f32 v15, 0x3f317218, v15
    v_mul_f32 v11, v11, v7
    v_fma_f32 v16, v16, v15, v16
    v_mul_f32 v18, s90, v11
    v_cvt_pk_bf16_f32 v16, v16, v16
    v_fma_f32 v19, v11, s90, -v18
    v_lshlrev_b32 v16, 16, v16
    v_fma_f32 v19, v11, s91, v19
    v_mul_f32 v16, v16, v7
    v_mul_f32 v20, v12, v8
    v_mul_f32 v21, v13, v8
    v_mul_f32 v17, 0xbfb8aa3b, v16
    ds_write_b32 v4, v18 offset:128
    ds_write_b32 v4, v19 offset:256
    ds_write_b32 v4, v20 offset:384
    ds_write_b32 v4, v21 offset:512
    ds_write_b32 v4, v17 offset:0
    s_waitcnt lgkmcnt(0)
    ds_read_b128 v[40:43], v9 offset:0
    ds_read_b128 v[44:47], v9 offset:128
    ds_read_b128 v[48:51], v9 offset:256
    ds_read_b128 v[52:55], v9 offset:384
    ds_read_b128 v[56:59], v9 offset:512
    ds_read_b128 v[60:63], v9 offset:32
    ds_read_b128 v[64:67], v9 offset:160
    ds_read_b128 v[68:71], v9 offset:288
    ds_read_b128 v[72:75], v9 offset:416
    ds_read_b128 v[76:79], v9 offset:544
    s_waitcnt lgkmcnt(5)
    v_mul_f32 v10, v44, v5
    v_mul_f32 v17, v44, v6
    v_mul_f32 v22, v45, v5
    v_mul_f32 v29, v45, v6
    v_mul_f32 v12, v40, v5
    v_mul_f32 v19, v40, v6
    v_mul_f32 v24, v41, v5
    v_mul_f32 v31, v41, v6
    v_fma_f32 v11, v44, v5, -v10
    v_fma_f32 v18, v44, v6, -v17
    v_fma_f32 v23, v45, v5, -v22
    v_fma_f32 v30, v45, v6, -v29
    v_exp_f32 v12, v12
    v_exp_f32 v19, v19
    v_exp_f32 v24, v24
    v_exp_f32 v31, v31
    v_fma_f32 v11, v48, v5, v11
    v_fma_f32 v18, v48, v6, v18
    v_fma_f32 v23, v49, v5, v23
    v_fma_f32 v30, v49, v6, v30
    v_fract_f32 v10, v10
    v_fract_f32 v17, v17
    v_fract_f32 v22, v22
    v_fract_f32 v29, v29
    v_add_f32 v10, v10, v11
    v_add_f32 v17, v17, v18
    v_add_f32 v22, v22, v23
    v_add_f32 v29, v29, v30
    v_sin_f32 v13, v10
    v_cos_f32 v14, v10
    v_sin_f32 v25, v22
    v_cos_f32 v26, v22
    v_sin_f32 v20, v17
    v_cos_f32 v21, v17
    v_sin_f32 v32, v29
    v_cos_f32 v33, v29
    v_mul_f32 v15, v56, v13
    v_mul_f32 v16, v56, v14
    v_mul_f32 v27, v57, v25
    v_mul_f32 v28, v57, v26
    v_fma_f32 v15, v52, v14, -v15
    v_fma_f32 v16, v52, v13, v16
    v_fma_f32 v27, v53, v26, -v27
    v_fma_f32 v28, v53, v25, v28
    v_mul_f32 v104, v19, v21
    v_mul_f32 v105, v19, v20
    v_mul_f32 v106, v31, v33
    v_mul_f32 v107, v31, v32
    v_mul_f32 v96, v12, v15
    v_mul_f32_e64 v97, -v12, v16
    v_mul_f32 v98, v24, v27
    v_mul_f32_e64 v99, -v24, v28
    v_cvt_pk_bf16_f32 v120, v104, v105
    v_cvt_pk_bf16_f32 v112, v96, v97
    v_cvt_pk_bf16_f32 v121, v106, v107
    v_cvt_pk_bf16_f32 v113, v98, v99
    v_lshlrev_b32 v10, 16, v120
    v_and_b32 v11, 0xffff0000, v120
    v_lshlrev_b32 v17, 16, v112
    v_and_b32 v18, 0xffff0000, v112
    v_lshlrev_b32 v22, 16, v121
    v_and_b32 v23, 0xffff0000, v121
    v_lshlrev_b32 v29, 16, v113
    v_and_b32 v30, 0xffff0000, v113
    v_sub_f32 v104, v104, v10
    v_sub_f32 v105, v105, v11
    v_sub_f32 v96, v96, v17
    v_sub_f32 v97, v97, v18
    v_cvt_pk_bf16_f32 v124, v104, v105
    v_cvt_pk_bf16_f32 v116, v96, v97
    v_sub_f32 v106, v106, v22
    v_sub_f32 v107, v107, v23
    v_sub_f32 v98, v98, v29
    v_sub_f32 v99, v99, v30
    v_cvt_pk_bf16_f32 v125, v106, v107
    v_cvt_pk_bf16_f32 v117, v98, v99
    v_mul_f32 v10, v46, v5
    v_mul_f32 v17, v46, v6
    v_mul_f32 v22, v47, v5
    v_mul_f32 v29, v47, v6
    v_mul_f32 v12, v42, v5
    v_mul_f32 v19, v42, v6
    v_mul_f32 v24, v43, v5
    v_mul_f32 v31, v43, v6
    v_fma_f32 v11, v46, v5, -v10
    v_fma_f32 v18, v46, v6, -v17
    v_fma_f32 v23, v47, v5, -v22
    v_fma_f32 v30, v47, v6, -v29
    v_exp_f32 v12, v12
    v_exp_f32 v19, v19
    v_exp_f32 v24, v24
    v_exp_f32 v31, v31
    v_fma_f32 v11, v50, v5, v11
    v_fma_f32 v18, v50, v6, v18
    v_fma_f32 v23, v51, v5, v23
    v_fma_f32 v30, v51, v6, v30
    v_fract_f32 v10, v10
    v_fract_f32 v17, v17
    v_fract_f32 v22, v22
    v_fract_f32 v29, v29
    v_add_f32 v10, v10, v11
    v_add_f32 v17, v17, v18
    v_add_f32 v22, v22, v23
    v_add_f32 v29, v29, v30
    v_sin_f32 v13, v10
    v_cos_f32 v14, v10
    v_sin_f32 v25, v22
    v_cos_f32 v26, v22
    v_sin_f32 v20, v17
    v_cos_f32 v21, v17
    v_sin_f32 v32, v29
    v_cos_f32 v33, v29
    v_mul_f32 v15, v58, v13
    v_mul_f32 v16, v58, v14
    v_mul_f32 v27, v59, v25
    v_mul_f32 v28, v59, v26
    v_fma_f32 v15, v54, v14, -v15
    v_fma_f32 v16, v54, v13, v16
    v_fma_f32 v27, v55, v26, -v27
    v_fma_f32 v28, v55, v25, v28
    v_mul_f32 v108, v19, v21
    v_mul_f32 v109, v19, v20
    v_mul_f32 v110, v31, v33
    v_mul_f32 v111, v31, v32
    v_mul_f32 v100, v12, v15
    v_mul_f32_e64 v101, -v12, v16
    v_mul_f32 v102, v24, v27
    v_mul_f32_e64 v103, -v24, v28
    v_cvt_pk_bf16_f32 v122, v108, v109
    v_cvt_pk_bf16_f32 v114, v100, v101
    v_cvt_pk_bf16_f32 v123, v110, v111
    v_cvt_pk_bf16_f32 v115, v102, v103
    v_lshlrev_b32 v10, 16, v122
    v_and_b32 v11, 0xffff0000, v122
    v_lshlrev_b32 v17, 16, v114
    v_and_b32 v18, 0xffff0000, v114
    v_lshlrev_b32 v22, 16, v123
    v_and_b32 v23, 0xffff0000, v123
    v_lshlrev_b32 v29, 16, v115
    v_and_b32 v30, 0xffff0000, v115
    v_sub_f32 v108, v108, v10
    v_sub_f32 v109, v109, v11
    v_sub_f32 v100, v100, v17
    v_sub_f32 v101, v101, v18
    v_cvt_pk_bf16_f32 v126, v108, v109
    v_cvt_pk_bf16_f32 v118, v100, v101
    v_sub_f32 v110, v110, v22
    v_sub_f32 v111, v111, v23
    v_sub_f32 v102, v102, v29
    v_sub_f32 v103, v103, v30
    v_cvt_pk_bf16_f32 v127, v110, v111
    v_cvt_pk_bf16_f32 v119, v102, v103
    s_nop 1
    v_mfma_f32_32x32x16_bf16 v[80:95], v[112:115], v[120:123], v[80:95]
    v_mfma_f32_32x32x16_bf16 v[80:95], v[112:115], v[124:127], v[80:95]
    v_mfma_f32_32x32x16_bf16 v[80:95], v[116:119], v[120:123], v[80:95]
    ds_read_b128 v[40:43], v9 offset:64
    ds_read_b128 v[44:47], v9 offset:192
    ds_read_b128 v[48:51], v9 offset:320
    ds_read_b128 v[52:55], v9 offset:448
    ds_read_b128 v[56:59], v9 offset:576
    s_waitcnt lgkmcnt(5)
    v_mul_f32 v10, v64, v5
    v_mul_f32 v17, v64, v6
    v_mul_f32 v22, v65, v5
    v_mul_f32 v29, v65, v6
    v_mul_f32 v12, v60, v5
    v_mul_f32 v19, v60, v6
    v_mul_f32 v24, v61, v5
    v_mul_f32 v31, v61, v6
    v_fma_f32 v11, v64, v5, -v10
    v_fma_f32 v18, v64, v6, -v17
    v_fma_f32 v23, v65, v5, -v22
    v_fma_f32 v30, v65, v6, -v29
    v_exp_f32 v12, v12
    v_exp_f32 v19, v19
    v_exp_f32 v24, v24
    v_exp_f32 v31, v31
    v_fma_f32 v11, v68, v5, v11
    v_fma_f32 v18, v68, v6, v18
    v_fma_f32 v23, v69, v5, v23
    v_fma_f32 v30, v69, v6, v30
    v_fract_f32 v10, v10
    v_fract_f32 v17, v17
    v_fract_f32 v22, v22
    v_fract_f32 v29, v29
    v_add_f32 v10, v10, v11
    v_add_f32 v17, v17, v18
    v_add_f32 v22, v22, v23
    v_add_f32 v29, v29, v30
    v_sin_f32 v13, v10
    v_cos_f32 v14, v10
    v_sin_f32 v25, v22
    v_cos_f32 v26, v22
    v_sin_f32 v20, v17
    v_cos_f32 v21, v17
    v_sin_f32 v32, v29
    v_cos_f32 v33, v29
    v_mul_f32 v15, v76, v13
    v_mul_f32 v16, v76, v14
    v_mul_f32 v27, v77, v25
    v_mul_f32 v28, v77, v26
    v_fma_f32 v15, v72, v14, -v15
    v_fma_f32 v16, v72, v13, v16
    v_fma_f32 v27, v73, v26, -v27
    v_fma_f32 v28, v73, v25, v28
    v_mul_f32 v104, v19, v21
    v_mul_f32 v105, v19, v20
    v_mul_f32 v106, v31, v33
    v_mul_f32 v107, v31, v32
    v_mul_f32 v96, v12, v15
    v_mul_f32_e64 v97, -v12, v16
    v_mul_f32 v98, v24, v27
    v_mul_f32_e64 v99, -v24, v28
    v_cvt_pk_bf16_f32 v120, v104, v105
    v_cvt_pk_bf16_f32 v112, v96, v97
    v_cvt_pk_bf16_f32 v121, v106, v107
    v_cvt_pk_bf16_f32 v113, v98, v99
    v_lshlrev_b32 v10, 16, v120
    v_and_b32 v11, 0xffff0000, v120
    v_lshlrev_b32 v17, 16, v112
    v_and_b32 v18, 0xffff0000, v112
    v_lshlrev_b32 v22, 16, v121
    v_and_b32 v23, 0xffff0000, v121
    v_lshlrev_b32 v29, 16, v113
    v_and_b32 v30, 0xffff0000, v113
    v_sub_f32 v104, v104, v10
    v_sub_f32 v105, v105, v11
    v_sub_f32 v96, v96, v17
    v_sub_f32 v97, v97, v18
    v_cvt_pk_bf16_f32 v124, v104, v105
    v_cvt_pk_bf16_f32 v116, v96, v97
    v_sub_f32 v106, v106, v22
    v_sub_f32 v107, v107, v23
    v_sub_f32 v98, v98, v29
    v_sub_f32 v99, v99, v30
    v_cvt_pk_bf16_f32 v125, v106, v107
    v_cvt_pk_bf16_f32 v117, v98, v99
    v_mul_f32 v10, v66, v5
    v_mul_f32 v17, v66, v6
    v_mul_f32 v22, v67, v5
    v_mul_f32 v29, v67, v6
    v_mul_f32 v12, v62, v5
    v_mul_f32 v19, v62, v6
    v_mul_f32 v24, v63, v5
    v_mul_f32 v31, v63, v6
    v_fma_f32 v11, v66, v5, -v10
    v_fma_f32 v18, v66, v6, -v17
    v_fma_f32 v23, v67, v5, -v22
    v_fma_f32 v30, v67, v6, -v29
    v_exp_f32 v12, v12
    v_exp_f32 v19, v19
    v_exp_f32 v24, v24
    v_exp_f32 v31, v31
    v_fma_f32 v11, v70, v5, v11
    v_fma_f32 v18, v70, v6, v18
    v_fma_f32 v23, v71, v5, v23
    v_fma_f32 v30, v71, v6, v30
    v_fract_f32 v10, v10
    v_fract_f32 v17, v17
    v_fract_f32 v22, v22
    v_fract_f32 v29, v29
    v_add_f32 v10, v10, v11
    v_add_f32 v17, v17, v18
    v_add_f32 v22, v22, v23
    v_add_f32 v29, v29, v30
    v_sin_f32 v13, v10
    v_cos_f32 v14, v10
    v_sin_f32 v25, v22
    v_cos_f32 v26, v22
    v_sin_f32 v20, v17
    v_cos_f32 v21, v17
    v_sin_f32 v32, v29
    v_cos_f32 v33, v29
    v_mul_f32 v15, v78, v13
    v_mul_f32 v16, v78, v14
    v_mul_f32 v27, v79, v25
    v_mul_f32 v28, v79, v26
    v_fma_f32 v15, v74, v14, -v15
    v_fma_f32 v16, v74, v13, v16
    v_fma_f32 v27, v75, v26, -v27
    v_fma_f32 v28, v75, v25, v28
    v_mul_f32 v108, v19, v21
    v_mul_f32 v109, v19, v20
    v_mul_f32 v110, v31, v33
    v_mul_f32 v111, v31, v32
    v_mul_f32 v100, v12, v15
    v_mul_f32_e64 v101, -v12, v16
    v_mul_f32 v102, v24, v27
    v_mul_f32_e64 v103, -v24, v28
    v_cvt_pk_bf16_f32 v122, v108, v109
    v_cvt_pk_bf16_f32 v114, v100, v101
    v_cvt_pk_bf16_f32 v123, v110, v111
    v_cvt_pk_bf16_f32 v115, v102, v103
    v_lshlrev_b32 v10, 16, v122
    v_and_b32 v11, 0xffff0000, v122
    v_lshlrev_b32 v17, 16, v114
    v_and_b32 v18, 0xffff0000, v114
    v_lshlrev_b32 v22, 16, v123
    v_and_b32 v23, 0xffff0000, v123
    v_lshlrev_b32 v29, 16, v115
    v_and_b32 v30, 0xffff0000, v115
    v_sub_f32 v108, v108, v10
    v_sub_f32 v109, v109, v11
    v_sub_f32 v100, v100, v17
    v_sub_f32 v101, v101, v18
    v_cvt_pk_bf16_f32 v126, v108, v109
    v_cvt_pk_bf16_f32 v118, v100, v101
    v_sub_f32 v110, v110, v22
    v_sub_f32 v111, v111, v23
    v_sub_f32 v102, v102, v29
    v_sub_f32 v103, v103, v30
    v_cvt_pk_bf16_f32 v127, v110, v111
    v_cvt_pk_bf16_f32 v119, v102, v103
    s_nop 1
    v_mfma_f32_32x32x16_bf16 v[80:95], v[112:115], v[120:123], v[80:95]
    v_mfma_f32_32x32x16_bf16 v[80:95], v[112:115], v[124:127], v[80:95]
    v_mfma_f32_32x32x16_bf16 v[80:95], v[116:119], v[120:123], v[80:95]
    ds_read_b128 v[60:63], v9 offset:96
    ds_read_b128 v[64:67], v9 offset:224
    ds_read_b128 v[68:71], v9 offset:352
    ds_read_b128 v[72:75], v9 offset:480
    ds_read_b128 v[76:79], v9 offset:608
    s_waitcnt lgkmcnt(5)
    v_mul_f32 v10, v44, v5
    v_mul_f32 v17, v44, v6
    v_mul_f32 v22, v45, v5
    v_mul_f32 v29, v45, v6
    v_mul_f32 v12, v40, v5
    v_mul_f32 v19, v40, v6
    v_mul_f32 v24, v41, v5
    v_mul_f32 v31, v41, v6
    v_fma_f32 v11, v44, v5, -v10
    v_fma_f32 v18, v44, v6, -v17
    v_fma_f32 v23, v45, v5, -v22
    v_fma_f32 v30, v45, v6, -v29
    v_exp_f32 v12, v12
    v_exp_f32 v19, v19
    v_exp_f32 v24, v24
    v_exp_f32 v31, v31
    v_fma_f32 v11, v48, v5, v11
    v_fma_f32 v18, v48, v6, v18
    v_fma_f32 v23, v49, v5, v23
    v_fma_f32 v30, v49, v6, v30
    v_fract_f32 v10, v10
    v_fract_f32 v17, v17
    v_fract_f32 v22, v22
    v_fract_f32 v29, v29
    v_add_f32 v10, v10, v11
    v_add_f32 v17, v17, v18
    v_add_f32 v22, v22, v23
    v_add_f32 v29, v29, v30
    v_sin_f32 v13, v10
    v_cos_f32 v14, v10
    v_sin_f32 v25, v22
    v_cos_f32 v26, v22
    v_sin_f32 v20, v17
    v_cos_f32 v21, v17
    v_sin_f32 v32, v29
    v_cos_f32 v33, v29
    v_mul_f32 v15, v56, v13
    v_mul_f32 v16, v56, v14
    v_mul_f32 v27, v57, v25
    v_mul_f32 v28, v57, v26
    v_fma_f32 v15, v52, v14, -v15
    v_fma_f32 v16, v52, v13, v16
    v_fma_f32 v27, v53, v26, -v27
    v_fma_f32 v28, v53, v25, v28
    v_mul_f32 v104, v19, v21
    v_mul_f32 v105, v19, v20
    v_mul_f32 v106, v31, v33
    v_mul_f32 v107, v31, v32
    v_mul_f32 v96, v12, v15
    v_mul_f32_e64 v97, -v12, v16
    v_mul_f32 v98, v24, v27
    v_mul_f32_e64 v99, -v24, v28
    v_cvt_pk_bf16_f32 v120, v104, v105
    v_cvt_pk_bf16_f32 v112, v96, v97
    v_cvt_pk_bf16_f32 v121, v106, v107
    v_cvt_pk_bf16_f32 v113, v98, v99
    v_lshlrev_b32 v10, 16, v120
    v_and_b32 v11, 0xffff0000, v120
    v_lshlrev_b32 v17, 16, v112
    v_and_b32 v18, 0xffff0000, v112
    v_lshlrev_b32 v22, 16, v121
    v_and_b32 v23, 0xffff0000, v121
    v_lshlrev_b32 v29, 16, v113
    v_and_b32 v30, 0xffff0000, v113
    v_sub_f32 v104, v104, v10
    v_sub_f32 v105, v105, v11
    v_sub_f32 v96, v96, v17
    v_sub_f32 v97, v97, v18
    v_cvt_pk_bf16_f32 v124, v104, v105
    v_cvt_pk_bf16_f32 v116, v96, v97
    v_sub_f32 v106, v106, v22
    v_sub_f32 v107, v107, v23
    v_sub_f32 v98, v98, v29
    v_sub_f32 v99, v99, v30
    v_cvt_pk_bf16_f32 v125, v106, v107
    v_cvt_pk_bf16_f32 v117, v98, v99
    v_mul_f32 v10, v46, v5
    v_mul_f32 v17, v46, v6
    v_mul_f32 v22, v47, v5
    v_mul_f32 v29, v47, v6
    v_mul_f32 v12, v42, v5
    v_mul_f32 v19, v42, v6
    v_mul_f32 v24, v43, v5
    v_mul_f32 v31, v43, v6
    v_fma_f32 v11, v46, v5, -v10
    v_fma_f32 v18, v46, v6, -v17
    v_fma_f32 v23, v47, v5, -v22
    v_fma_f32 v30, v47, v6, -v29
    v_exp_f32 v12, v12
    v_exp_f32 v19, v19
    v_exp_f32 v24, v24
    v_exp_f32 v31, v31
    v_fma_f32 v11, v50, v5, v11
    v_fma_f32 v18, v50, v6, v18
    v_fma_f32 v23, v51, v5, v23
    v_fma_f32 v30, v51, v6, v30
    v_fract_f32 v10, v10
    v_fract_f32 v17, v17
    v_fract_f32 v22, v22
    v_fract_f32 v29, v29
    v_add_f32 v10, v10, v11
    v_add_f32 v17, v17, v18
    v_add_f32 v22, v22, v23
    v_add_f32 v29, v29, v30
    v_sin_f32 v13, v10
    v_cos_f32 v14, v10
    v_sin_f32 v25, v22
    v_cos_f32 v26, v22
    v_sin_f32 v20, v17
    v_cos_f32 v21, v17
    v_sin_f32 v32, v29
    v_cos_f32 v33, v29
    v_mul_f32 v15, v58, v13
    v_mul_f32 v16, v58, v14
    v_mul_f32 v27, v59, v25
    v_mul_f32 v28, v59, v26
    v_fma_f32 v15, v54, v14, -v15
    v_fma_f32 v16, v54, v13, v16
    v_fma_f32 v27, v55, v26, -v27
    v_fma_f32 v28, v55, v25, v28
    v_mul_f32 v108, v19, v21
    v_mul_f32 v109, v19, v20
    v_mul_f32 v110, v31, v33
    v_mul_f32 v111, v31, v32
    v_mul_f32 v100, v12, v15
    v_mul_f32_e64 v101, -v12, v16
    v_mul_f32 v102, v24, v27
    v_mul_f32_e64 v103, -v24, v28
    v_cvt_pk_bf16_f32 v122, v108, v109
    v_cvt_pk_bf16_f32 v114, v100, v101
    v_cvt_pk_bf16_f32 v123, v110, v111
    v_cvt_pk_bf16_f32 v115, v102, v103
    v_lshlrev_b32 v10, 16, v122
    v_and_b32 v11, 0xffff0000, v122
    v_lshlrev_b32 v17, 16, v114
    v_and_b32 v18, 0xffff0000, v114
    v_lshlrev_b32 v22, 16, v123
    v_and_b32 v23, 0xffff0000, v123
    v_lshlrev_b32 v29, 16, v115
    v_and_b32 v30, 0xffff0000, v115
    v_sub_f32 v108, v108, v10
    v_sub_f32 v109, v109, v11
    v_sub_f32 v100, v100, v17
    v_sub_f32 v101, v101, v18
    v_cvt_pk_bf16_f32 v126, v108, v109
    v_cvt_pk_bf16_f32 v118, v100, v101
    v_sub_f32 v110, v110, v22
    v_sub_f32 v111, v111, v23
    v_sub_f32 v102, v102, v29
    v_sub_f32 v103, v103, v30
    v_cvt_pk_bf16_f32 v127, v110, v111
    v_cvt_pk_bf16_f32 v119, v102, v103
    s_nop 1
    v_mfma_f32_32x32x16_bf16 v[80:95], v[112:115], v[120:123], v[80:95]
    v_mfma_f32_32x32x16_bf16 v[80:95], v[112:115], v[124:127], v[80:95]
    v_mfma_f32_32x32x16_bf16 v[80:95], v[116:119], v[120:123], v[80:95]
    s_waitcnt lgkmcnt(0)
    v_mul_f32 v10, v64, v5
    v_mul_f32 v17, v64, v6
    v_mul_f32 v22, v65, v5
    v_mul_f32 v29, v65, v6
    v_mul_f32 v12, v60, v5
    v_mul_f32 v19, v60, v6
    v_mul_f32 v24, v61, v5
    v_mul_f32 v31, v61, v6
    v_fma_f32 v11, v64, v5, -v10
    v_fma_f32 v18, v64, v6, -v17
    v_fma_f32 v23, v65, v5, -v22
    v_fma_f32 v30, v65, v6, -v29
    v_exp_f32 v12, v12
    v_exp_f32 v19, v19
    v_exp_f32 v24, v24
    v_exp_f32 v31, v31
    v_fma_f32 v11, v68, v5, v11
    v_fma_f32 v18, v68, v6, v18
    v_fma_f32 v23, v69, v5, v23
    v_fma_f32 v30, v69, v6, v30
    v_fract_f32 v10, v10
    v_fract_f32 v17, v17
    v_fract_f32 v22, v22
    v_fract_f32 v29, v29
    v_add_f32 v10, v10, v11
    v_add_f32 v17, v17, v18
    v_add_f32 v22, v22, v23
    v_add_f32 v29, v29, v30
    v_sin_f32 v13, v10
    v_cos_f32 v14, v10
    v_sin_f32 v25, v22
    v_cos_f32 v26, v22
    v_sin_f32 v20, v17
    v_cos_f32 v21, v17
    v_sin_f32 v32, v29
    v_cos_f32 v33, v29
    v_mul_f32 v15, v76, v13
    v_mul_f32 v16, v76, v14
    v_mul_f32 v27, v77, v25
    v_mul_f32 v28, v77, v26
    v_fma_f32 v15, v72, v14, -v15
    v_fma_f32 v16, v72, v13, v16
    v_fma_f32 v27, v73, v26, -v27
    v_fma_f32 v28, v73, v25, v28
    v_mul_f32 v104, v19, v21
    v_mul_f32 v105, v19, v20
    v_mul_f32 v106, v31, v33
    v_mul_f32 v107, v31, v32
    v_mul_f32 v96, v12, v15
    v_mul_f32_e64 v97, -v12, v16
    v_mul_f32 v98, v24, v27
    v_mul_f32_e64 v99, -v24, v28
    v_cvt_pk_bf16_f32 v120, v104, v105
    v_cvt_pk_bf16_f32 v112, v96, v97
    v_cvt_pk_bf16_f32 v121, v106, v107
    v_cvt_pk_bf16_f32 v113, v98, v99
    v_lshlrev_b32 v10, 16, v120
    v_and_b32 v11, 0xffff0000, v120
    v_lshlrev_b32 v17, 16, v112
    v_and_b32 v18, 0xffff0000, v112
    v_lshlrev_b32 v22, 16, v121
    v_and_b32 v23, 0xffff0000, v121
    v_lshlrev_b32 v29, 16, v113
    v_and_b32 v30, 0xffff0000, v113
    v_sub_f32 v104, v104, v10
    v_sub_f32 v105, v105, v11
    v_sub_f32 v96, v96, v17
    v_sub_f32 v97, v97, v18
    v_cvt_pk_bf16_f32 v124, v104, v105
    v_cvt_pk_bf16_f32 v116, v96, v97
    v_sub_f32 v106, v106, v22
    v_sub_f32 v107, v107, v23
    v_sub_f32 v98, v98, v29
    v_sub_f32 v99, v99, v30
    v_cvt_pk_bf16_f32 v125, v106, v107
    v_cvt_pk_bf16_f32 v117, v98, v99
    v_mul_f32 v10, v66, v5
    v_mul_f32 v17, v66, v6
    v_mul_f32 v22, v67, v5
    v_mul_f32 v29, v67, v6
    v_mul_f32 v12, v62, v5
    v_mul_f32 v19, v62, v6
    v_mul_f32 v24, v63, v5
    v_mul_f32 v31, v63, v6
    v_fma_f32 v11, v66, v5, -v10
    v_fma_f32 v18, v66, v6, -v17
    v_fma_f32 v23, v67, v5, -v22
    v_fma_f32 v30, v67, v6, -v29
    v_exp_f32 v12, v12
    v_exp_f32 v19, v19
    v_exp_f32 v24, v24
    v_exp_f32 v31, v31
    v_fma_f32 v11, v70, v5, v11
    v_fma_f32 v18, v70, v6, v18
    v_fma_f32 v23, v71, v5, v23
    v_fma_f32 v30, v71, v6, v30
    v_fract_f32 v10, v10
    v_fract_f32 v17, v17
    v_fract_f32 v22, v22
    v_fract_f32 v29, v29
    v_add_f32 v10, v10, v11
    v_add_f32 v17, v17, v18
    v_add_f32 v22, v22, v23
    v_add_f32 v29, v29, v30
    v_sin_f32 v13, v10
    v_cos_f32 v14, v10
    v_sin_f32 v25, v22
    v_cos_f32 v26, v22
    v_sin_f32 v20, v17
    v_cos_f32 v21, v17
    v_sin_f32 v32, v29
    v_cos_f32 v33, v29
    v_mul_f32 v15, v78, v13
    v_mul_f32 v16, v78, v14
    v_mul_f32 v27, v79, v25
    v_mul_f32 v28, v79, v26
    v_fma_f32 v15, v74, v14, -v15
    v_fma_f32 v16, v74, v13, v16
    v_fma_f32 v27, v75, v26, -v27
    v_fma_f32 v28, v75, v25, v28
    v_mul_f32 v108, v19, v21
    v_mul_f32 v109, v19, v20
    v_mul_f32 v110, v31, v33
    v_mul_f32 v111, v31, v32
    v_mul_f32 v100, v12, v15
    v_mul_f32_e64 v101, -v12, v16
    v_mul_f32 v102, v24, v27
    v_mul_f32_e64 v103, -v24, v28
    v_cvt_pk_bf16_f32 v122, v108, v109
    v_cvt_pk_bf16_f32 v114, v100, v101
    v_cvt_pk_bf16_f32 v123, v110, v111
    v_cvt_pk_bf16_f32 v115, v102, v103
    v_lshlrev_b32 v10, 16, v122
    v_and_b32 v11, 0xffff0000, v122
    v_lshlrev_b32 v17, 16, v114
    v_and_b32 v18, 0xffff0000, v114
    v_lshlrev_b32 v22, 16, v123
    v_and_b32 v23, 0xffff0000, v123
    v_lshlrev_b32 v29, 16, v115
    v_and_b32 v30, 0xffff0000, v115
    v_sub_f32 v108, v108, v10
    v_sub_f32 v109, v109, v11
    v_sub_f32 v100, v100, v17
    v_sub_f32 v101, v101, v18
    v_cvt_pk_bf16_f32 v126, v108, v109
    v_cvt_pk_bf16_f32 v118, v100, v101
    v_sub_f32 v110, v110, v22
    v_sub_f32 v111, v111, v23
    v_sub_f32 v102, v102, v29
    v_sub_f32 v103, v103, v30
    v_cvt_pk_bf16_f32 v127, v110, v111
    v_cvt_pk_bf16_f32 v119, v102, v103
    s_nop 1
    v_mfma_f32_32x32x16_bf16 v[80:95], v[112:115], v[120:123], v[80:95]
    v_mfma_f32_32x32x16_bf16 v[80:95], v[112:115], v[124:127], v[80:95]
    v_mfma_f32_32x32x16_bf16 v[80:95], v[116:119], v[120:123], v[80:95]
    s_lshl_b32 s84, s3, 12
    v_lshlrev_b32 v10, 4, v2
    v_add_u32 v11, s84, v10
    s_lshl_b32 s84, s3, 10
    v_add_u32 v12, s84, v10
    s_lshl_b32 s85, s2, 12
    s_add_u32 s85, s85, s84
    s_add_u32 s85, s85, 2097152
    s_nop 10
    ds_write_b128 v11, v[80:83] offset:0
    ds_write_b128 v11, v[84:87] offset:1024
    ds_write_b128 v11, v[88:91] offset:2048
    s_waitcnt lgkmcnt(0)
    s_barrier
    s_cmp_eq_u32 s3, 3
    s_cbranch_scc1 k1_end
    ds_read_b128 v[40:43], v12 offset:0
    ds_read_b128 v[44:47], v12 offset:4096
    ds_read_b128 v[48:51], v12 offset:8192
    ds_read_b128 v[52:55], v12 offset:12288
    s_waitcnt lgkmcnt(0)
    v_add_f32 v40, v40, v44
    v_add_f32 v48, v48, v52
    v_add_f32 v41, v41, v45
    v_add_f32 v49, v49, v53
    v_add_f32 v42, v42, v46
    v_add_f32 v50, v50, v54
    v_add_f32 v43, v43, v47
    v_add_f32 v51, v51, v55
    v_add_f32 v40, v40, v48
    v_add_f32 v41, v41, v49
    v_add_f32 v42, v42, v50
    v_add_f32 v43, v43, v51
    buffer_store_dwordx4 v[40:43], v10, s[80:83], s85 offen
    s_mov_b32 s2, s97
    s_endpgm
k1_ln:
    s_load_dwordx2 s[4:5], s[0:1], 0
    s_setprio 3
    s_mov_b32 s16, s2
    s_lshl_b32 s16, s16, 2
    s_add_u32 s16, s16, s3
    s_lshl_b32 s17, s16, 3
    s_lshl_b32 s18, s17, 10
    v_lshlrev_b32 v3, 4, v2
    s_waitcnt lgkmcnt(0)
    s_mov_b32 s80, s14
    s_and_b32 s81, s15, 0xffff
    s_mov_b32 s82, 0x01b00000
    s_mov_b32 s83, 0x00020000
    s_mov_b32 s84, s4
    s_and_b32 s85, s5, 0xffff
    s_mov_b32 s86, 0x200000
    s_mov_b32 s87, 0x00020000
    buffer_load_dwordx4 v[8:11], v3, s[84:87], s18 offen offset:0
    buffer_load_dwordx4 v[12:15], v3, s[84:87], s18 offen offset:1024
    buffer_load_dwordx4 v[16:19], v3, s[84:87], s18 offen offset:2048
    buffer_load_dwordx4 v[20:23], v3, s[84:87], s18 offen offset:3072
    s_add_u32 s18, s18, 4096
    buffer_load_dwordx4 v[24:27], v3, s[84:87], s18 offen offset:0
    buffer_load_dwordx4 v[28:31], v3, s[84:87], s18 offen offset:1024
    buffer_load_dwordx4 v[32:35], v3, s[84:87], s18 offen offset:2048
    buffer_load_dwordx4 v[36:39], v3, s[84:87], s18 offen offset:3072
    s_waitcnt vmcnt(7)
    v_lshlrev_b32 v40, 16, v8
    v_and_b32 v41, 0xffff0000, v8
    v_lshlrev_b32 v42, 16, v9
    v_and_b32 v43, 0xffff0000, v9
    v_lshlrev_b32 v44, 16, v10
    v_and_b32 v45, 0xffff0000, v10
    v_lshlrev_b32 v46, 16, v11
    v_and_b32 v47, 0xffff0000, v11
    v_pk_add_f32 v[4:5], v[40:41], v[42:43]
    v_pk_add_f32 v[6:7], v[44:45], v[46:47]
    v_pk_add_f32 v[4:5], v[4:5], v[6:7]
    v_add_f32 v104, v4, v5
    s_waitcnt vmcnt(6)
    v_lshlrev_b32 v48, 16, v12
    v_and_b32 v49, 0xffff0000, v12
    v_lshlrev_b32 v50, 16, v13
    v_and_b32 v51, 0xffff0000, v13
    v_lshlrev_b32 v52, 16, v14
    v_and_b32 v53, 0xffff0000, v14
    v_lshlrev_b32 v54, 16, v15
    v_and_b32 v55, 0xffff0000, v15
    v_pk_add_f32 v[4:5], v[48:49], v[50:51]
    v_pk_add_f32 v[6:7], v[52:53], v[54:55]
    v_pk_add_f32 v[4:5], v[4:5], v[6:7]
    v_add_f32 v105, v4, v5
    s_waitcnt vmcnt(5)
    v_lshlrev_b32 v56, 16, v16
    v_and_b32 v57, 0xffff0000, v16
    v_lshlrev_b32 v58, 16, v17
    v_and_b32 v59, 0xffff0000, v17
    v_lshlrev_b32 v60, 16, v18
    v_and_b32 v61, 0xffff0000, v18
    v_lshlrev_b32 v62, 16, v19
    v_and_b32 v63, 0xffff0000, v19
    v_pk_add_f32 v[4:5], v[56:57], v[58:59]
    v_pk_add_f32 v[6:7], v[60:61], v[62:63]
    v_pk_add_f32 v[4:5], v[4:5], v[6:7]
    v_add_f32 v106, v4, v5
    s_waitcnt vmcnt(4)
    v_lshlrev_b32 v64, 16, v20
    v_and_b32 v65, 0xffff0000, v20
    v_lshlrev_b32 v66, 16, v21
    v_and_b32 v67, 0xffff0000, v21
    v_lshlrev_b32 v68, 16, v22
    v_and_b32 v69, 0xffff0000, v22
    v_lshlrev_b32 v70, 16, v23
    v_and_b32 v71, 0xffff0000, v23
    v_pk_add_f32 v[4:5], v[64:65], v[66:67]
    v_pk_add_f32 v[6:7], v[68:69], v[70:71]
    v_pk_add_f32 v[4:5], v[4:5], v[6:7]
    v_add_f32 v107, v4, v5
    s_waitcnt vmcnt(3)
    v_lshlrev_b32 v72, 16, v24
    v_and_b32 v73, 0xffff0000, v24
    v_lshlrev_b32 v74, 16, v25
    v_and_b32 v75, 0xffff0000, v25
    v_lshlrev_b32 v76, 16, v26
    v_and_b32 v77, 0xffff0000, v26
    v_lshlrev_b32 v78, 16, v27
    v_and_b32 v79, 0xffff0000, v27
    v_pk_add_f32 v[4:5], v[72:73], v[74:75]
    v_pk_add_f32 v[6:7], v[76:77], v[78:79]
    v_pk_add_f32 v[4:5], v[4:5], v[6:7]
    v_add_f32 v108, v4, v5
    s_waitcnt vmcnt(2)
    v_lshlrev_b32 v80, 16, v28
    v_and_b32 v81, 0xffff0000, v28
    v_lshlrev_b32 v82, 16, v29
    v_and_b32 v83, 0xffff0000, v29
    v_lshlrev_b32 v84, 16, v30
    v_and_b32 v85, 0xffff0000, v30
    v_lshlrev_b32 v86, 16, v31
    v_and_b32 v87, 0xffff0000, v31
    v_pk_add_f32 v[4:5], v[80:81], v[82:83]
    v_pk_add_f32 v[6:7], v[84:85], v[86:87]
    v_pk_add_f32 v[4:5], v[4:5], v[6:7]
    v_add_f32 v109, v4, v5
    s_waitcnt vmcnt(1)
    v_lshlrev_b32 v88, 16, v32
    v_and_b32 v89, 0xffff0000, v32
    v_lshlrev_b32 v90, 16, v33
    v_and_b32 v91, 0xffff0000, v33
    v_lshlrev_b32 v92, 16, v34
    v_and_b32 v93, 0xffff0000, v34
    v_lshlrev_b32 v94, 16, v35
    v_and_b32 v95, 0xffff0000, v35
    v_pk_add_f32 v[4:5], v[88:89], v[90:91]
    v_pk_add_f32 v[6:7], v[92:93], v[94:95]
    v_pk_add_f32 v[4:5], v[4:5], v[6:7]
    v_add_f32 v110, v4, v5
    s_waitcnt vmcnt(0)
    v_lshlrev_b32 v96, 16, v36
    v_and_b32 v97, 0xffff0000, v36
    v_lshlrev_b32 v98, 16, v37
    v_and_b32 v99, 0xffff0000, v37
    v_lshlrev_b32 v100, 16, v38
    v_and_b32 v101, 0xffff0000, v38
    v_lshlrev_b32 v102, 16, v39
    v_and_b32 v103, 0xffff0000, v39
    v_pk_add_f32 v[4:5], v[96:97], v[98:99]
    v_pk_add_f32 v[6:7], v[100:101], v[102:103]
    v_pk_add_f32 v[4:5], v[4:5], v[6:7]
    v_add_f32 v111, v4, v5
    s_nop 1
    v_add_f32_dpp v104, v104, v104 row_shr:1 row_mask:0xf bank_mask:0xf bound_ctrl:0
    v_add_f32_dpp v105, v105, v105 row_shr:1 row_mask:0xf bank_mask:0xf bound_ctrl:0
    v_add_f32_dpp v106, v106, v106 row_shr:1 row_mask:0xf bank_mask:0xf bound_ctrl:0
    v_add_f32_dpp v107, v107, v107 row_shr:1 row_mask:0xf bank_mask:0xf bound_ctrl:0
    v_add_f32_dpp v108, v108, v108 row_shr:1 row_mask:0xf bank_mask:0xf bound_ctrl:0
    v_add_f32_dpp v109, v109, v109 row_shr:1 row_mask:0xf bank_mask:0xf bound_ctrl:0
    v_add_f32_dpp v110, v110, v110 row_shr:1 row_mask:0xf bank_mask:0xf bound_ctrl:0
    v_add_f32_dpp v111, v111, v111 row_shr:1 row_mask:0xf bank_mask:0xf bound_ctrl:0
    v_add_f32_dpp v104, v104, v104 row_shr:2 row_mask:0xf bank_mask:0xf bound_ctrl:0
    v_add_f32_dpp v105, v105, v105 row_shr:2 row_mask:0xf bank_mask:0xf bound_ctrl:0
    v_add_f32_dpp v106, v106, v106 row_shr:2 row_mask:0xf bank_mask:0xf bound_ctrl:0
    v_add_f32_dpp v107, v107, v107 row_shr:2 row_mask:0xf bank_mask:0xf bound_ctrl:0
    v_add_f32_dpp v108, v108, v108 row_shr:2 row_mask:0xf bank_mask:0xf bound_ctrl:0
    v_add_f32_dpp v109, v109, v109 row_shr:2 row_mask:0xf bank_mask:0xf bound_ctrl:0
    v_add_f32_dpp v110, v110, v110 row_shr:2 row_mask:0xf bank_mask:0xf bound_ctrl:0
    v_add_f32_dpp v111, v111, v111 row_shr:2 row_mask:0xf bank_mask:0xf bound_ctrl:0
    v_add_f32_dpp v104, v104, v104 row_shr:4 row_mask:0xf bank_mask:0xf bound_ctrl:0
    v_add_f32_dpp v105, v105, v105 row_shr:4 row_mask:0xf bank_mask:0xf bound_ctrl:0
    v_add_f32_dpp v106, v106, v106 row_shr:4 row_mask:0xf bank_mask:0xf bound_ctrl:0
    v_add_f32_dpp v107, v107, v107 row_shr:4 row_mask:0xf bank_mask:0xf bound_ctrl:0
    v_add_f32_dpp v108, v108, v108 row_shr:4 row_mask:0xf bank_mask:0xf bound_ctrl:0
    v_add_f32_dpp v109, v109, v109 row_shr:4 row_mask:0xf bank_mask:0xf bound_ctrl:0
    v_add_f32_dpp v110, v110, v110 row_shr:4 row_mask:0xf bank_mask:0xf bound_ctrl:0
    v_add_f32_dpp v111, v111, v111 row_shr:4 row_mask:0xf bank_mask:0xf bound_ctrl:0
    v_add_f32_dpp v104, v104, v104 row_shr:8 row_mask:0xf bank_mask:0xf bound_ctrl:0
    v_add_f32_dpp v105, v105, v105 row_shr:8 row_mask:0xf bank_mask:0xf bound_ctrl:0
    v_add_f32_dpp v106, v106, v106 row_shr:8 row_mask:0xf bank_mask:0xf bound_ctrl:0
    v_add_f32_dpp v107, v107, v107 row_shr:8 row_mask:0xf bank_mask:0xf bound_ctrl:0
    v_add_f32_dpp v108, v108, v108 row_shr:8 row_mask:0xf bank_mask:0xf bound_ctrl:0
    v_add_f32_dpp v109, v109, v109 row_shr:8 row_mask:0xf bank_mask:0xf bound_ctrl:0
    v_add_f32_dpp v110, v110, v110 row_shr:8 row_mask:0xf bank_mask:0xf bound_ctrl:0
    v_add_f32_dpp v111, v111, v111 row_shr:8 row_mask:0xf bank_mask:0xf bound_ctrl:0
    v_add_f32_dpp v104, v104, v104 row_bcast:15 row_mask:0xa bank_mask:0xf
    v_add_f32_dpp v105, v105, v105 row_bcast:15 row_mask:0xa bank_mask:0xf
    v_add_f32_dpp v106, v106, v106 row_bcast:15 row_mask:0xa bank_mask:0xf
    v_add_f32_dpp v107, v107, v107 row_bcast:15 row_mask:0xa bank_mask:0xf
    v_add_f32_dpp v108, v108, v108 row_bcast:15 row_mask:0xa bank_mask:0xf
    v_add_f32_dpp v109, v109, v109 row_bcast:15 row_mask:0xa bank_mask:0xf
    v_add_f32_dpp v110, v110, v110 row_bcast:15 row_mask:0xa bank_mask:0xf
    v_add_f32_dpp v111, v111, v111 row_bcast:15 row_mask:0xa bank_mask:0xf
    v_add_f32_dpp v104, v104, v104 row_bcast:31 row_mask:0xc bank_mask:0xf
    v_add_f32_dpp v105, v105, v105 row_bcast:31 row_mask:0xc bank_mask:0xf
    v_add_f32_dpp v106, v106, v106 row_bcast:31 row_mask:0xc bank_mask:0xf
    v_add_f32_dpp v107, v107, v107 row_bcast:31 row_mask:0xc bank_mask:0xf
    v_add_f32_dpp v108, v108, v108 row_bcast:31 row_mask:0xc bank_mask:0xf
    v_add_f32_dpp v109, v109, v109 row_bcast:31 row_mask:0xc bank_mask:0xf
    v_add_f32_dpp v110, v110, v110 row_bcast:31 row_mask:0xc bank_mask:0xf
    v_add_f32_dpp v111, v111, v111 row_bcast:31 row_mask:0xc bank_mask:0xf
    s_nop 1
    v_readlane_b32 s20, v104, 63
    v_readlane_b32 s21, v105, 63
    v_readlane_b32 s22, v106, 63
    v_readlane_b32 s23, v107, 63
    v_readlane_b32 s24, v108, 63
    v_readlane_b32 s25, v109, 63
    v_readlane_b32 s26, v110, 63
    v_readlane_b32 s27, v111, 63
    s_nop 1
    v_mov_b32 v8, s20
    v_mul_f32 v8, 0x3b000000, v8
    v_mov_b32 v12, s21
    v_mul_f32 v12, 0x3b000000, v12
    v_mov_b32 v16, s22
    v_mul_f32 v16, 0x3b000000, v16
    v_mov_b32 v20, s23
    v_mul_f32 v20, 0x3b000000, v20
    v_mov_b32 v24, s24
    v_mul_f32 v24, 0x3b000000, v24
    v_mov_b32 v28, s25
    v_mul_f32 v28, 0x3b000000, v28
    v_mov_b32 v32, s26
    v_mul_f32 v32, 0x3b000000, v32
    v_mov_b32 v36, s27
    v_mul_f32 v36, 0x3b000000, v36
    v_pk_add_f32 v[4:5], v[40:41], v[8:9] op_sel_hi:[1,0] neg_lo:[0,1] neg_hi:[0,1]
    v_pk_add_f32 v[6:7], v[42:43], v[8:9] op_sel_hi:[1,0] neg_lo:[0,1] neg_hi:[0,1]
    v_pk_mul_f32 v[112:113], v[4:5], v[4:5]
    v_pk_mul_f32 v[114:115], v[6:7], v[6:7]
    v_pk_add_f32 v[4:5], v[44:45], v[8:9] op_sel_hi:[1,0] neg_lo:[0,1] neg_hi:[0,1]
    v_pk_add_f32 v[6:7], v[46:47], v[8:9] op_sel_hi:[1,0] neg_lo:[0,1] neg_hi:[0,1]
    v_pk_fma_f32 v[112:113], v[4:5], v[4:5], v[112:113]
    v_pk_fma_f32 v[114:115], v[6:7], v[6:7], v[114:115]
    v_pk_add_f32 v[112:113], v[112:113], v[114:115]
    v_add_f32 v104, v112, v113
    v_pk_add_f32 v[4:5], v[48:49], v[12:13] op_sel_hi:[1,0] neg_lo:[0,1] neg_hi:[0,1]
    v_pk_add_f32 v[6:7], v[50:51], v[12:13] op_sel_hi:[1,0] neg_lo:[0,1] neg_hi:[0,1]
    v_pk_mul_f32 v[112:113], v[4:5], v[4:5]
    v_pk_mul_f32 v[114:115], v[6:7], v[6:7]
    v_pk_add_f32 v[4:5], v[52:53], v[12:13] op_sel_hi:[1,0] neg_lo:[0,1] neg_hi:[0,1]
    v_pk_add_f32 v[6:7], v[54:55], v[12:13] op_sel_hi:[1,0] neg_lo:[0,1] neg_hi:[0,1]
    v_pk_fma_f32 v[112:113], v[4:5], v[4:5], v[112:113]
    v_pk_fma_f32 v[114:115], v[6:7], v[6:7], v[114:115]
    v_pk_add_f32 v[112:113], v[112:113], v[114:115]
    v_add_f32 v105, v112, v113
    v_pk_add_f32 v[4:5], v[56:57], v[16:17] op_sel_hi:[1,0] neg_lo:[0,1] neg_hi:[0,1]
    v_pk_add_f32 v[6:7], v[58:59], v[16:17] op_sel_hi:[1,0] neg_lo:[0,1] neg_hi:[0,1]
    v_pk_mul_f32 v[112:113], v[4:5], v[4:5]
    v_pk_mul_f32 v[114:115], v[6:7], v[6:7]
    v_pk_add_f32 v[4:5], v[60:61], v[16:17] op_sel_hi:[1,0] neg_lo:[0,1] neg_hi:[0,1]
    v_pk_add_f32 v[6:7], v[62:63], v[16:17] op_sel_hi:[1,0] neg_lo:[0,1] neg_hi:[0,1]
    v_pk_fma_f32 v[112:113], v[4:5], v[4:5], v[112:113]
    v_pk_fma_f32 v[114:115], v[6:7], v[6:7], v[114:115]
    v_pk_add_f32 v[112:113], v[112:113], v[114:115]
    v_add_f32 v106, v112, v113
    v_pk_add_f32 v[4:5], v[64:65], v[20:21] op_sel_hi:[1,0] neg_lo:[0,1] neg_hi:[0,1]
    v_pk_add_f32 v[6:7], v[66:67], v[20:21] op_sel_hi:[1,0] neg_lo:[0,1] neg_hi:[0,1]
    v_pk_mul_f32 v[112:113], v[4:5], v[4:5]
    v_pk_mul_f32 v[114:115], v[6:7], v[6:7]
    v_pk_add_f32 v[4:5], v[68:69], v[20:21] op_sel_hi:[1,0] neg_lo:[0,1] neg_hi:[0,1]
    v_pk_add_f32 v[6:7], v[70:71], v[20:21] op_sel_hi:[1,0] neg_lo:[0,1] neg_hi:[0,1]
    v_pk_fma_f32 v[112:113], v[4:5], v[4:5], v[112:113]
    v_pk_fma_f32 v[114:115], v[6:7], v[6:7], v[114:115]
    v_pk_add_f32 v[112:113], v[112:113], v[114:115]
    v_add_f32 v107, v112, v113
    v_pk_add_f32 v[4:5], v[72:73], v[24:25] op_sel_hi:[1,0] neg_lo:[0,1] neg_hi:[0,1]
    v_pk_add_f32 v[6:7], v[74:75], v[24:25] op_sel_hi:[1,0] neg_lo:[0,1] neg_hi:[0,1]
    v_pk_mul_f32 v[112:113], v[4:5], v[4:5]
    v_pk_mul_f32 v[114:115], v[6:7], v[6:7]
    v_pk_add_f32 v[4:5], v[76:77], v[24:25] op_sel_hi:[1,0] neg_lo:[0,1] neg_hi:[0,1]
    v_pk_add_f32 v[6:7], v[78:79], v[24:25] op_sel_hi:[1,0] neg_lo:[0,1] neg_hi:[0,1]
    v_pk_fma_f32 v[112:113], v[4:5], v[4:5], v[112:113]
    v_pk_fma_f32 v[114:115], v[6:7], v[6:7], v[114:115]
    v_pk_add_f32 v[112:113], v[112:113], v[114:115]
    v_add_f32 v108, v112, v113
    v_pk_add_f32 v[4:5], v[80:81], v[28:29] op_sel_hi:[1,0] neg_lo:[0,1] neg_hi:[0,1]
    v_pk_add_f32 v[6:7], v[82:83], v[28:29] op_sel_hi:[1,0] neg_lo:[0,1] neg_hi:[0,1]
    v_pk_mul_f32 v[112:113], v[4:5], v[4:5]
    v_pk_mul_f32 v[114:115], v[6:7], v[6:7]
    v_pk_add_f32 v[4:5], v[84:85], v[28:29] op_sel_hi:[1,0] neg_lo:[0,1] neg_hi:[0,1]
    v_pk_add_f32 v[6:7], v[86:87], v[28:29] op_sel_hi:[1,0] neg_lo:[0,1] neg_hi:[0,1]
    v_pk_fma_f32 v[112:113], v[4:5], v[4:5], v[112:113]
    v_pk_fma_f32 v[114:115], v[6:7], v[6:7], v[114:115]
    v_pk_add_f32 v[112:113], v[112:113], v[114:115]
    v_add_f32 v109, v112, v113
    v_pk_add_f32 v[4:5], v[88:89], v[32:33] op_sel_hi:[1,0] neg_lo:[0,1] neg_hi:[0,1]
    v_pk_add_f32 v[6:7], v[90:91], v[32:33] op_sel_hi:[1,0] neg_lo:[0,1] neg_hi:[0,1]
    v_pk_mul_f32 v[112:113], v[4:5], v[4:5]
    v_pk_mul_f32 v[114:115], v[6:7], v[6:7]
    v_pk_add_f32 v[4:5], v[92:93], v[32:33] op_sel_hi:[1,0] neg_lo:[0,1] neg_hi:[0,1]
    v_pk_add_f32 v[6:7], v[94:95], v[32:33] op_sel_hi:[1,0] neg_lo:[0,1] neg_hi:[0,1]
    v_pk_fma_f32 v[112:113], v[4:5], v[4:5], v[112:113]
    v_pk_fma_f32 v[114:115], v[6:7], v[6:7], v[114:115]
    v_pk_add_f32 v[112:113], v[112:113], v[114:115]
    v_add_f32 v110, v112, v113
    v_pk_add_f32 v[4:5], v[96:97], v[36:37] op_sel_hi:[1,0] neg_lo:[0,1] neg_hi:[0,1]
    v_pk_add_f32 v[6:7], v[98:99], v[36:37] op_sel_hi:[1,0] neg_lo:[0,1] neg_hi:[0,1]
    v_pk_mul_f32 v[112:113], v[4:5], v[4:5]
    v_pk_mul_f32 v[114:115], v[6:7], v[6:7]
    v_pk_add_f32 v[4:5], v[100:101], v[36:37] op_sel_hi:[1,0] neg_lo:[0,1] neg_hi:[0,1]
    v_pk_add_f32 v[6:7], v[102:103], v[36:37] op_sel_hi:[1,0] neg_lo:[0,1] neg_hi:[0,1]
    v_pk_fma_f32 v[112:113], v[4:5], v[4:5], v[112:113]
    v_pk_fma_f32 v[114:115], v[6:7], v[6:7], v[114:115]
    v_pk_add_f32 v[112:113], v[112:113], v[114:115]
    v_add_f32 v111, v112, v113
    s_nop 1
    v_add_f32_dpp v104, v104, v104 row_shr:1 row_mask:0xf bank_mask:0xf bound_ctrl:0
    v_add_f32_dpp v105, v105, v105 row_shr:1 row_mask:0xf bank_mask:0xf bound_ctrl:0
    v_add_f32_dpp v106, v106, v106 row_shr:1 row_mask:0xf bank_mask:0xf bound_ctrl:0
    v_add_f32_dpp v107, v107, v107 row_shr:1 row_mask:0xf bank_mask:0xf bound_ctrl:0
    v_add_f32_dpp v108, v108, v108 row_shr:1 row_mask:0xf bank_mask:0xf bound_ctrl:0
    v_add_f32_dpp v109, v109, v109 row_shr:1 row_mask:0xf bank_mask:0xf bound_ctrl:0
    v_add_f32_dpp v110, v110, v110 row_shr:1 row_mask:0xf bank_mask:0xf bound_ctrl:0
    v_add_f32_dpp v111, v111, v111 row_shr:1 row_mask:0xf bank_mask:0xf bound_ctrl:0
    v_add_f32_dpp v104, v104, v104 row_shr:2 row_mask:0xf bank_mask:0xf bound_ctrl:0
    v_add_f32_dpp v105, v105, v105 row_shr:2 row_mask:0xf bank_mask:0xf bound_ctrl:0
    v_add_f32_dpp v106, v106, v106 row_shr:2 row_mask:0xf bank_mask:0xf bound_ctrl:0
    v_add_f32_dpp v107, v107, v107 row_shr:2 row_mask:0xf bank_mask:0xf bound_ctrl:0
    v_add_f32_dpp v108, v108, v108 row_shr:2 row_mask:0xf bank_mask:0xf bound_ctrl:0
    v_add_f32_dpp v109, v109, v109 row_shr:2 row_mask:0xf bank_mask:0xf bound_ctrl:0
    v_add_f32_dpp v110, v110, v110 row_shr:2 row_mask:0xf bank_mask:0xf bound_ctrl:0
    v_add_f32_dpp v111, v111, v111 row_shr:2 row_mask:0xf bank_mask:0xf bound_ctrl:0
    v_add_f32_dpp v104, v104, v104 row_shr:4 row_mask:0xf bank_mask:0xf bound_ctrl:0
    v_add_f32_dpp v105, v105, v105 row_shr:4 row_mask:0xf bank_mask:0xf bound_ctrl:0
    v_add_f32_dpp v106, v106, v106 row_shr:4 row_mask:0xf bank_mask:0xf bound_ctrl:0
    v_add_f32_dpp v107, v107, v107 row_shr:4 row_mask:0xf bank_mask:0xf bound_ctrl:0
    v_add_f32_dpp v108, v108, v108 row_shr:4 row_mask:0xf bank_mask:0xf bound_ctrl:0
    v_add_f32_dpp v109, v109, v109 row_shr:4 row_mask:0xf bank_mask:0xf bound_ctrl:0
    v_add_f32_dpp v110, v110, v110 row_shr:4 row_mask:0xf bank_mask:0xf bound_ctrl:0
    v_add_f32_dpp v111, v111, v111 row_shr:4 row_mask:0xf bank_mask:0xf bound_ctrl:0
    v_add_f32_dpp v104, v104, v104 row_shr:8 row_mask:0xf bank_mask:0xf bound_ctrl:0
    v_add_f32_dpp v105, v105, v105 row_shr:8 row_mask:0xf bank_mask:0xf bound_ctrl:0
    v_add_f32_dpp v106, v106, v106 row_shr:8 row_mask:0xf bank_mask:0xf bound_ctrl:0
    v_add_f32_dpp v107, v107, v107 row_shr:8 row_mask:0xf bank_mask:0xf bound_ctrl:0
    v_add_f32_dpp v108, v108, v108 row_shr:8 row_mask:0xf bank_mask:0xf bound_ctrl:0
    v_add_f32_dpp v109, v109, v109 row_shr:8 row_mask:0xf bank_mask:0xf bound_ctrl:0
    v_add_f32_dpp v110, v110, v110 row_shr:8 row_mask:0xf bank_mask:0xf bound_ctrl:0
    v_add_f32_dpp v111, v111, v111 row_shr:8 row_mask:0xf bank_mask:0xf bound_ctrl:0
    v_add_f32_dpp v104, v104, v104 row_bcast:15 row_mask:0xa bank_mask:0xf
    v_add_f32_dpp v105, v105, v105 row_bcast:15 row_mask:0xa bank_mask:0xf
    v_add_f32_dpp v106, v106, v106 row_bcast:15 row_mask:0xa bank_mask:0xf
    v_add_f32_dpp v107, v107, v107 row_bcast:15 row_mask:0xa bank_mask:0xf
    v_add_f32_dpp v108, v108, v108 row_bcast:15 row_mask:0xa bank_mask:0xf
    v_add_f32_dpp v109, v109, v109 row_bcast:15 row_mask:0xa bank_mask:0xf
    v_add_f32_dpp v110, v110, v110 row_bcast:15 row_mask:0xa bank_mask:0xf
    v_add_f32_dpp v111, v111, v111 row_bcast:15 row_mask:0xa bank_mask:0xf
    v_add_f32_dpp v104, v104, v104 row_bcast:31 row_mask:0xc bank_mask:0xf
    v_add_f32_dpp v105, v105, v105 row_bcast:31 row_mask:0xc bank_mask:0xf
    v_add_f32_dpp v106, v106, v106 row_bcast:31 row_mask:0xc bank_mask:0xf
    v_add_f32_dpp v107, v107, v107 row_bcast:31 row_mask:0xc bank_mask:0xf
    v_add_f32_dpp v108, v108, v108 row_bcast:31 row_mask:0xc bank_mask:0xf
    v_add_f32_dpp v109, v109, v109 row_bcast:31 row_mask:0xc bank_mask:0xf
    v_add_f32_dpp v110, v110, v110 row_bcast:31 row_mask:0xc bank_mask:0xf
    v_add_f32_dpp v111, v111, v111 row_bcast:31 row_mask:0xc bank_mask:0xf
    s_nop 1
    v_readlane_b32 s32, v104, 63
    v_readlane_b32 s33, v105, 63
    v_readlane_b32 s34, v106, 63
    v_readlane_b32 s35, v107, 63
    v_readlane_b32 s36, v108, 63
    v_readlane_b32 s37, v109, 63
    v_readlane_b32 s38, v110, 63
    v_readlane_b32 s39, v111, 63
    s_nop 1
    v_mov_b32 v4, s32
    v_mul_f32 v4, 0x3b000000, v4
    v_cvt_pk_bf16_f32 v4, v4, v8
    v_and_b32 v8, 0xffff0000, v4
    v_lshlrev_b32 v4, 16, v4
    v_add_f32 v4, 0x3727c5ac, v4
    v_cvt_pk_bf16_f32 v4, v4, v4
    v_lshlrev_b32 v4, 16, v4
    v_sqrt_f32 v4, v4
    s_nop 0
    v_cvt_pk_bf16_f32 v4, v4, v4
    v_lshlrev_b32 v10, 16, v4
    v_rcp_f32 v112, v10
    v_mov_b32 v4, s33
    v_mul_f32 v4, 0x3b000000, v4
    v_cvt_pk_bf16_f32 v4, v4, v12
    v_and_b32 v12, 0xffff0000, v4
    v_lshlrev_b32 v4, 16, v4
    v_add_f32 v4, 0x3727c5ac, v4
    v_cvt_pk_bf16_f32 v4, v4, v4
    v_lshlrev_b32 v4, 16, v4
    v_sqrt_f32 v4, v4
    s_nop 0
    v_cvt_pk_bf16_f32 v4, v4, v4
    v_lshlrev_b32 v14, 16, v4
    v_rcp_f32 v114, v14
    v_mov_b32 v4, s34
    v_mul_f32 v4, 0x3b000000, v4
    v_cvt_pk_bf16_f32 v4, v4, v16
    v_and_b32 v16, 0xffff0000, v4
    v_lshlrev_b32 v4, 16, v4
    v_add_f32 v4, 0x3727c5ac, v4
    v_cvt_pk_bf16_f32 v4, v4, v4
    v_lshlrev_b32 v4, 16, v4
    v_sqrt_f32 v4, v4
    s_nop 0
    v_cvt_pk_bf16_f32 v4, v4, v4
    v_lshlrev_b32 v18, 16, v4
    v_rcp_f32 v116, v18
    v_mov_b32 v4, s35
    v_mul_f32 v4, 0x3b000000, v4
    v_cvt_pk_bf16_f32 v4, v4, v20
    v_and_b32 v20, 0xffff0000, v4
    v_lshlrev_b32 v4, 16, v4
    v_add_f32 v4, 0x3727c5ac, v4
    v_cvt_pk_bf16_f32 v4, v4, v4
    v_lshlrev_b32 v4, 16, v4
    v_sqrt_f32 v4, v4
    s_nop 0
    v_cvt_pk_bf16_f32 v4, v4, v4
    v_lshlrev_b32 v22, 16, v4
    v_rcp_f32 v118, v22
    v_mov_b32 v4, s36
    v_mul_f32 v4, 0x3b000000, v4
    v_cvt_pk_bf16_f32 v4, v4, v24
    v_and_b32 v24, 0xffff0000, v4
    v_lshlrev_b32 v4, 16, v4
    v_add_f32 v4, 0x3727c5ac, v4
    v_cvt_pk_bf16_f32 v4, v4, v4
    v_lshlrev_b32 v4, 16, v4
    v_sqrt_f32 v4, v4
    s_nop 0
    v_cvt_pk_bf16_f32 v4, v4, v4
    v_lshlrev_b32 v26, 16, v4
    v_rcp_f32 v120, v26
    v_mov_b32 v4, s37
    v_mul_f32 v4, 0x3b000000, v4
    v_cvt_pk_bf16_f32 v4, v4, v28
    v_and_b32 v28, 0xffff0000, v4
    v_lshlrev_b32 v4, 16, v4
    v_add_f32 v4, 0x3727c5ac, v4
    v_cvt_pk_bf16_f32 v4, v4, v4
    v_lshlrev_b32 v4, 16, v4
    v_sqrt_f32 v4, v4
    s_nop 0
    v_cvt_pk_bf16_f32 v4, v4, v4
    v_lshlrev_b32 v30, 16, v4
    v_rcp_f32 v122, v30
    v_mov_b32 v4, s38
    v_mul_f32 v4, 0x3b000000, v4
    v_cvt_pk_bf16_f32 v4, v4, v32
    v_and_b32 v32, 0xffff0000, v4
    v_lshlrev_b32 v4, 16, v4
    v_add_f32 v4, 0x3727c5ac, v4
    v_cvt_pk_bf16_f32 v4, v4, v4
    v_lshlrev_b32 v4, 16, v4
    v_sqrt_f32 v4, v4
    s_nop 0
    v_cvt_pk_bf16_f32 v4, v4, v4
    v_lshlrev_b32 v34, 16, v4
    v_rcp_f32 v124, v34
    v_mov_b32 v4, s39
    v_mul_f32 v4, 0x3b000000, v4
    v_cvt_pk_bf16_f32 v4, v4, v36
    v_and_b32 v36, 0xffff0000, v4
    v_lshlrev_b32 v4, 16, v4
    v_add_f32 v4, 0x3727c5ac, v4
    v_cvt_pk_bf16_f32 v4, v4, v4
    v_lshlrev_b32 v4, 16, v4
    v_sqrt_f32 v4, v4
    s_nop 0
    v_cvt_pk_bf16_f32 v4, v4, v4
    v_lshlrev_b32 v38, 16, v4
    v_rcp_f32 v6, v38
    v_lshrrev_b32 v3, 1, v2
    v_lshlrev_b32 v3, 10, v3
    v_and_b32 v4, 1, v2
    v_lshl_add_u32 v3, v4, 9, v3
    s_lshr_b32 s19, s17, 5
    s_lshl_b32 s19, s19, 15
    s_and_b32 s18, s17, 31
    s_lshl_b32 s18, s18, 4
    s_add_u32 s18, s18, s19
    v_pk_add_f32 v[4:5], v[40:41], v[8:9] op_sel_hi:[1,0] neg_lo:[0,1] neg_hi:[0,1]
    v_cvt_pk_bf16_f32 v4, v4, v5
    v_and_b32 v5, 0xffff0000, v4
    v_lshlrev_b32 v4, 16, v4
    v_pk_mul_f32 v[40:41], v[4:5], v[112:113] op_sel_hi:[1,0]
    v_pk_fma_f32 v[4:5], v[40:41], v[10:11], v[4:5] op_sel_hi:[1,0,1] neg_lo:[1,0,0] neg_hi:[1,0,0]
    v_pk_fma_f32 v[40:41], v[4:5], v[112:113], v[40:41] op_sel_hi:[1,0,1]
    v_cvt_pk_bf16_f32 v104, v40, v41
    v_pk_add_f32 v[4:5], v[42:43], v[8:9] op_sel_hi:[1,0] neg_lo:[0,1] neg_hi:[0,1]
    v_cvt_pk_bf16_f32 v4, v4, v5
    v_and_b32 v5, 0xffff0000, v4
    v_lshlrev_b32 v4, 16, v4
    v_pk_mul_f32 v[42:43], v[4:5], v[112:113] op_sel_hi:[1,0]
    v_pk_fma_f32 v[4:5], v[42:43], v[10:11], v[4:5] op_sel_hi:[1,0,1] neg_lo:[1,0,0] neg_hi:[1,0,0]
    v_pk_fma_f32 v[42:43], v[4:5], v[112:113], v[42:43] op_sel_hi:[1,0,1]
    v_cvt_pk_bf16_f32 v105, v42, v43
    v_pk_add_f32 v[4:5], v[44:45], v[8:9] op_sel_hi:[1,0] neg_lo:[0,1] neg_hi:[0,1]
    v_cvt_pk_bf16_f32 v4, v4, v5
    v_and_b32 v5, 0xffff0000, v4
    v_lshlrev_b32 v4, 16, v4
    v_pk_mul_f32 v[44:45], v[4:5], v[112:113] op_sel_hi:[1,0]
    v_pk_fma_f32 v[4:5], v[44:45], v[10:11], v[4:5] op_sel_hi:[1,0,1] neg_lo:[1,0,0] neg_hi:[1,0,0]
    v_pk_fma_f32 v[44:45], v[4:5], v[112:113], v[44:45] op_sel_hi:[1,0,1]
    v_cvt_pk_bf16_f32 v106, v44, v45
    v_pk_add_f32 v[4:5], v[46:47], v[8:9] op_sel_hi:[1,0] neg_lo:[0,1] neg_hi:[0,1]
    v_cvt_pk_bf16_f32 v4, v4, v5
    v_and_b32 v5, 0xffff0000, v4
    v_lshlrev_b32 v4, 16, v4
    v_pk_mul_f32 v[46:47], v[4:5], v[112:113] op_sel_hi:[1,0]
    v_pk_fma_f32 v[4:5], v[46:47], v[10:11], v[4:5] op_sel_hi:[1,0,1] neg_lo:[1,0,0] neg_hi:[1,0,0]
    v_pk_fma_f32 v[46:47], v[4:5], v[112:113], v[46:47] op_sel_hi:[1,0,1]
    v_cvt_pk_bf16_f32 v107, v46, v47
    buffer_store_dwordx4 v[104:107], v3, s[80:83], s18 offen offset:0
    v_pk_add_f32 v[4:5], v[48:49], v[12:13] op_sel_hi:[1,0] neg_lo:[0,1] neg_hi:[0,1]
    v_cvt_pk_bf16_f32 v4, v4, v5
    v_and_b32 v5, 0xffff0000, v4
    v_lshlrev_b32 v4, 16, v4
    v_pk_mul_f32 v[48:49], v[4:5], v[114:115] op_sel_hi:[1,0]
    v_pk_fma_f32 v[4:5], v[48:49], v[14:15], v[4:5] op_sel_hi:[1,0,1] neg_lo:[1,0,0] neg_hi:[1,0,0]
    v_pk_fma_f32 v[48:49], v[4:5], v[114:115], v[48:49] op_sel_hi:[1,0,1]
    v_cvt_pk_bf16_f32 v108, v48, v49
    v_pk_add_f32 v[4:5], v[50:51], v[12:13] op_sel_hi:[1,0] neg_lo:[0,1] neg_hi:[0,1]
    v_cvt_pk_bf16_f32 v4, v4, v5
    v_and_b32 v5, 0xffff0000, v4
    v_lshlrev_b32 v4, 16, v4
    v_pk_mul_f32 v[50:51], v[4:5], v[114:115] op_sel_hi:[1,0]
    v_pk_fma_f32 v[4:5], v[50:51], v[14:15], v[4:5] op_sel_hi:[1,0,1] neg_lo:[1,0,0] neg_hi:[1,0,0]
    v_pk_fma_f32 v[50:51], v[4:5], v[114:115], v[50:51] op_sel_hi:[1,0,1]
    v_cvt_pk_bf16_f32 v109, v50, v51
    v_pk_add_f32 v[4:5], v[52:53], v[12:13] op_sel_hi:[1,0] neg_lo:[0,1] neg_hi:[0,1]
    v_cvt_pk_bf16_f32 v4, v4, v5
    v_and_b32 v5, 0xffff0000, v4
    v_lshlrev_b32 v4, 16, v4
    v_pk_mul_f32 v[52:53], v[4:5], v[114:115] op_sel_hi:[1,0]
    v_pk_fma_f32 v[4:5], v[52:53], v[14:15], v[4:5] op_sel_hi:[1,0,1] neg_lo:[1,0,0] neg_hi:[1,0,0]
    v_pk_fma_f32 v[52:53], v[4:5], v[114:115], v[52:53] op_sel_hi:[1,0,1]
    v_cvt_pk_bf16_f32 v110, v52, v53
    v_pk_add_f32 v[4:5], v[54:55], v[12:13] op_sel_hi:[1,0] neg_lo:[0,1] neg_hi:[0,1]
    v_cvt_pk_bf16_f32 v4, v4, v5
    v_and_b32 v5, 0xffff0000, v4
    v_lshlrev_b32 v4, 16, v4
    v_pk_mul_f32 v[54:55], v[4:5], v[114:115] op_sel_hi:[1,0]
    v_pk_fma_f32 v[4:5], v[54:55], v[14:15], v[4:5] op_sel_hi:[1,0,1] neg_lo:[1,0,0] neg_hi:[1,0,0]
    v_pk_fma_f32 v[54:55], v[4:5], v[114:115], v[54:55] op_sel_hi:[1,0,1]
    v_cvt_pk_bf16_f32 v111, v54, v55
    buffer_store_dwordx4 v[108:111], v3, s[80:83], s18 offen offset:16
    v_pk_add_f32 v[4:5], v[56:57], v[16:17] op_sel_hi:[1,0] neg_lo:[0,1] neg_hi:[0,1]
    v_cvt_pk_bf16_f32 v4, v4, v5
    v_and_b32 v5, 0xffff0000, v4
    v_lshlrev_b32 v4, 16, v4
    v_pk_mul_f32 v[56:57], v[4:5], v[116:117] op_sel_hi:[1,0]
    v_pk_fma_f32 v[4:5], v[56:57], v[18:19], v[4:5] op_sel_hi:[1,0,1] neg_lo:[1,0,0] neg_hi:[1,0,0]
    v_pk_fma_f32 v[56:57], v[4:5], v[116:117], v[56:57] op_sel_hi:[1,0,1]
    v_cvt_pk_bf16_f32 v104, v56, v57
    v_pk_add_f32 v[4:5], v[58:59], v[16:17] op_sel_hi:[1,0] neg_lo:[0,1] neg_hi:[0,1]
    v_cvt_pk_bf16_f32 v4, v4, v5
    v_and_b32 v5, 0xffff0000, v4
    v_lshlrev_b32 v4, 16, v4
    v_pk_mul_f32 v[58:59], v[4:5], v[116:117] op_sel_hi:[1,0]
    v_pk_fma_f32 v[4:5], v[58:59], v[18:19], v[4:5] op_sel_hi:[1,0,1] neg_lo:[1,0,0] neg_hi:[1,0,0]
    v_pk_fma_f32 v[58:59], v[4:5], v[116:117], v[58:59] op_sel_hi:[1,0,1]
    v_cvt_pk_bf16_f32 v105, v58, v59
    v_pk_add_f32 v[4:5], v[60:61], v[16:17] op_sel_hi:[1,0] neg_lo:[0,1] neg_hi:[0,1]
    v_cvt_pk_bf16_f32 v4, v4, v5
    v_and_b32 v5, 0xffff0000, v4
    v_lshlrev_b32 v4, 16, v4
    v_pk_mul_f32 v[60:61], v[4:5], v[116:117] op_sel_hi:[1,0]
    v_pk_fma_f32 v[4:5], v[60:61], v[18:19], v[4:5] op_sel_hi:[1,0,1] neg_lo:[1,0,0] neg_hi:[1,0,0]
    v_pk_fma_f32 v[60:61], v[4:5], v[116:117], v[60:61] op_sel_hi:[1,0,1]
    v_cvt_pk_bf16_f32 v106, v60, v61
    v_pk_add_f32 v[4:5], v[62:63], v[16:17] op_sel_hi:[1,0] neg_lo:[0,1] neg_hi:[0,1]
    v_cvt_pk_bf16_f32 v4, v4, v5
    v_and_b32 v5, 0xffff0000, v4
    v_lshlrev_b32 v4, 16, v4
    v_pk_mul_f32 v[62:63], v[4:5], v[116:117] op_sel_hi:[1,0]
    v_pk_fma_f32 v[4:5], v[62:63], v[18:19], v[4:5] op_sel_hi:[1,0,1] neg_lo:[1,0,0] neg_hi:[1,0,0]
    v_pk_fma_f32 v[62:63], v[4:5], v[116:117], v[62:63] op_sel_hi:[1,0,1]
    v_cvt_pk_bf16_f32 v107, v62, v63
    buffer_store_dwordx4 v[104:107], v3, s[80:83], s18 offen offset:32
    v_pk_add_f32 v[4:5], v[64:65], v[20:21] op_sel_hi:[1,0] neg_lo:[0,1] neg_hi:[0,1]
    v_cvt_pk_bf16_f32 v4, v4, v5
    v_and_b32 v5, 0xffff0000, v4
    v_lshlrev_b32 v4, 16, v4
    v_pk_mul_f32 v[64:65], v[4:5], v[118:119] op_sel_hi:[1,0]
    v_pk_fma_f32 v[4:5], v[64:65], v[22:23], v[4:5] op_sel_hi:[1,0,1] neg_lo:[1,0,0] neg_hi:[1,0,0]
    v_pk_fma_f32 v[64:65], v[4:5], v[118:119], v[64:65] op_sel_hi:[1,0,1]
    v_cvt_pk_bf16_f32 v108, v64, v65
    v_pk_add_f32 v[4:5], v[66:67], v[20:21] op_sel_hi:[1,0] neg_lo:[0,1] neg_hi:[0,1]
    v_cvt_pk_bf16_f32 v4, v4, v5
    v_and_b32 v5, 0xffff0000, v4
    v_lshlrev_b32 v4, 16, v4
    v_pk_mul_f32 v[66:67], v[4:5], v[118:119] op_sel_hi:[1,0]
    v_pk_fma_f32 v[4:5], v[66:67], v[22:23], v[4:5] op_sel_hi:[1,0,1] neg_lo:[1,0,0] neg_hi:[1,0,0]
    v_pk_fma_f32 v[66:67], v[4:5], v[118:119], v[66:67] op_sel_hi:[1,0,1]
    v_cvt_pk_bf16_f32 v109, v66, v67
    v_pk_add_f32 v[4:5], v[68:69], v[20:21] op_sel_hi:[1,0] neg_lo:[0,1] neg_hi:[0,1]
    v_cvt_pk_bf16_f32 v4, v4, v5
    v_and_b32 v5, 0xffff0000, v4
    v_lshlrev_b32 v4, 16, v4
    v_pk_mul_f32 v[68:69], v[4:5], v[118:119] op_sel_hi:[1,0]
    v_pk_fma_f32 v[4:5], v[68:69], v[22:23], v[4:5] op_sel_hi:[1,0,1] neg_lo:[1,0,0] neg_hi:[1,0,0]
    v_pk_fma_f32 v[68:69], v[4:5], v[118:119], v[68:69] op_sel_hi:[1,0,1]
    v_cvt_pk_bf16_f32 v110, v68, v69
    v_pk_add_f32 v[4:5], v[70:71], v[20:21] op_sel_hi:[1,0] neg_lo:[0,1] neg_hi:[0,1]
    v_cvt_pk_bf16_f32 v4, v4, v5
    v_and_b32 v5, 0xffff0000, v4
    v_lshlrev_b32 v4, 16, v4
    v_pk_mul_f32 v[70:71], v[4:5], v[118:119] op_sel_hi:[1,0]
    v_pk_fma_f32 v[4:5], v[70:71], v[22:23], v[4:5] op_sel_hi:[1,0,1] neg_lo:[1,0,0] neg_hi:[1,0,0]
    v_pk_fma_f32 v[70:71], v[4:5], v[118:119], v[70:71] op_sel_hi:[1,0,1]
    v_cvt_pk_bf16_f32 v111, v70, v71
    buffer_store_dwordx4 v[108:111], v3, s[80:83], s18 offen offset:48
    v_pk_add_f32 v[4:5], v[72:73], v[24:25] op_sel_hi:[1,0] neg_lo:[0,1] neg_hi:[0,1]
    v_cvt_pk_bf16_f32 v4, v4, v5
    v_and_b32 v5, 0xffff0000, v4
    v_lshlrev_b32 v4, 16, v4
    v_pk_mul_f32 v[72:73], v[4:5], v[120:121] op_sel_hi:[1,0]
    v_pk_fma_f32 v[4:5], v[72:73], v[26:27], v[4:5] op_sel_hi:[1,0,1] neg_lo:[1,0,0] neg_hi:[1,0,0]
    v_pk_fma_f32 v[72:73], v[4:5], v[120:121], v[72:73] op_sel_hi:[1,0,1]
    v_cvt_pk_bf16_f32 v104, v72, v73
    v_pk_add_f32 v[4:5], v[74:75], v[24:25] op_sel_hi:[1,0] neg_lo:[0,1] neg_hi:[0,1]
    v_cvt_pk_bf16_f32 v4, v4, v5
    v_and_b32 v5, 0xffff0000, v4
    v_lshlrev_b32 v4, 16, v4
    v_pk_mul_f32 v[74:75], v[4:5], v[120:121] op_sel_hi:[1,0]
    v_pk_fma_f32 v[4:5], v[74:75], v[26:27], v[4:5] op_sel_hi:[1,0,1] neg_lo:[1,0,0] neg_hi:[1,0,0]
    v_pk_fma_f32 v[74:75], v[4:5], v[120:121], v[74:75] op_sel_hi:[1,0,1]
    v_cvt_pk_bf16_f32 v105, v74, v75
    v_pk_add_f32 v[4:5], v[76:77], v[24:25] op_sel_hi:[1,0] neg_lo:[0,1] neg_hi:[0,1]
    v_cvt_pk_bf16_f32 v4, v4, v5
    v_and_b32 v5, 0xffff0000, v4
    v_lshlrev_b32 v4, 16, v4
    v_pk_mul_f32 v[76:77], v[4:5], v[120:121] op_sel_hi:[1,0]
    v_pk_fma_f32 v[4:5], v[76:77], v[26:27], v[4:5] op_sel_hi:[1,0,1] neg_lo:[1,0,0] neg_hi:[1,0,0]
    v_pk_fma_f32 v[76:77], v[4:5], v[120:121], v[76:77] op_sel_hi:[1,0,1]
    v_cvt_pk_bf16_f32 v106, v76, v77
    v_pk_add_f32 v[4:5], v[78:79], v[24:25] op_sel_hi:[1,0] neg_lo:[0,1] neg_hi:[0,1]
    v_cvt_pk_bf16_f32 v4, v4, v5
    v_and_b32 v5, 0xffff0000, v4
    v_lshlrev_b32 v4, 16, v4
    v_pk_mul_f32 v[78:79], v[4:5], v[120:121] op_sel_hi:[1,0]
    v_pk_fma_f32 v[4:5], v[78:79], v[26:27], v[4:5] op_sel_hi:[1,0,1] neg_lo:[1,0,0] neg_hi:[1,0,0]
    v_pk_fma_f32 v[78:79], v[4:5], v[120:121], v[78:79] op_sel_hi:[1,0,1]
    v_cvt_pk_bf16_f32 v107, v78, v79
    buffer_store_dwordx4 v[104:107], v3, s[80:83], s18 offen offset:64
    v_pk_add_f32 v[4:5], v[80:81], v[28:29] op_sel_hi:[1,0] neg_lo:[0,1] neg_hi:[0,1]
    v_cvt_pk_bf16_f32 v4, v4, v5
    v_and_b32 v5, 0xffff0000, v4
    v_lshlrev_b32 v4, 16, v4
    v_pk_mul_f32 v[80:81], v[4:5], v[122:123] op_sel_hi:[1,0]
    v_pk_fma_f32 v[4:5], v[80:81], v[30:31], v[4:5] op_sel_hi:[1,0,1] neg_lo:[1,0,0] neg_hi:[1,0,0]
    v_pk_fma_f32 v[80:81], v[4:5], v[122:123], v[80:81] op_sel_hi:[1,0,1]
    v_cvt_pk_bf16_f32 v108, v80, v81
    v_pk_add_f32 v[4:5], v[82:83], v[28:29] op_sel_hi:[1,0] neg_lo:[0,1] neg_hi:[0,1]
    v_cvt_pk_bf16_f32 v4, v4, v5
    v_and_b32 v5, 0xffff0000, v4
    v_lshlrev_b32 v4, 16, v4
    v_pk_mul_f32 v[82:83], v[4:5], v[122:123] op_sel_hi:[1,0]
    v_pk_fma_f32 v[4:5], v[82:83], v[30:31], v[4:5] op_sel_hi:[1,0,1] neg_lo:[1,0,0] neg_hi:[1,0,0]
    v_pk_fma_f32 v[82:83], v[4:5], v[122:123], v[82:83] op_sel_hi:[1,0,1]
    v_cvt_pk_bf16_f32 v109, v82, v83
    v_pk_add_f32 v[4:5], v[84:85], v[28:29] op_sel_hi:[1,0] neg_lo:[0,1] neg_hi:[0,1]
    v_cvt_pk_bf16_f32 v4, v4, v5
    v_and_b32 v5, 0xffff0000, v4
    v_lshlrev_b32 v4, 16, v4
    v_pk_mul_f32 v[84:85], v[4:5], v[122:123] op_sel_hi:[1,0]
    v_pk_fma_f32 v[4:5], v[84:85], v[30:31], v[4:5] op_sel_hi:[1,0,1] neg_lo:[1,0,0] neg_hi:[1,0,0]
    v_pk_fma_f32 v[84:85], v[4:5], v[122:123], v[84:85] op_sel_hi:[1,0,1]
    v_cvt_pk_bf16_f32 v110, v84, v85
    v_pk_add_f32 v[4:5], v[86:87], v[28:29] op_sel_hi:[1,0] neg_lo:[0,1] neg_hi:[0,1]
    v_cvt_pk_bf16_f32 v4, v4, v5
    v_and_b32 v5, 0xffff0000, v4
    v_lshlrev_b32 v4, 16, v4
    v_pk_mul_f32 v[86:87], v[4:5], v[122:123] op_sel_hi:[1,0]
    v_pk_fma_f32 v[4:5], v[86:87], v[30:31], v[4:5] op_sel_hi:[1,0,1] neg_lo:[1,0,0] neg_hi:[1,0,0]
    v_pk_fma_f32 v[86:87], v[4:5], v[122:123], v[86:87] op_sel_hi:[1,0,1]
    v_cvt_pk_bf16_f32 v111, v86, v87
    buffer_store_dwordx4 v[108:111], v3, s[80:83], s18 offen offset:80
    v_pk_add_f32 v[4:5], v[88:89], v[32:33] op_sel_hi:[1,0] neg_lo:[0,1] neg_hi:[0,1]
    v_cvt_pk_bf16_f32 v4, v4, v5
    v_and_b32 v5, 0xffff0000, v4
    v_lshlrev_b32 v4, 16, v4
    v_pk_mul_f32 v[88:89], v[4:5], v[124:125] op_sel_hi:[1,0]
    v_pk_fma_f32 v[4:5], v[88:89], v[34:35], v[4:5] op_sel_hi:[1,0,1] neg_lo:[1,0,0] neg_hi:[1,0,0]
    v_pk_fma_f32 v[88:89], v[4:5], v[124:125], v[88:89] op_sel_hi:[1,0,1]
    v_cvt_pk_bf16_f32 v104, v88, v89
    v_pk_add_f32 v[4:5], v[90:91], v[32:33] op_sel_hi:[1,0] neg_lo:[0,1] neg_hi:[0,1]
    v_cvt_pk_bf16_f32 v4, v4, v5
    v_and_b32 v5, 0xffff0000, v4
    v_lshlrev_b32 v4, 16, v4
    v_pk_mul_f32 v[90:91], v[4:5], v[124:125] op_sel_hi:[1,0]
    v_pk_fma_f32 v[4:5], v[90:91], v[34:35], v[4:5] op_sel_hi:[1,0,1] neg_lo:[1,0,0] neg_hi:[1,0,0]
    v_pk_fma_f32 v[90:91], v[4:5], v[124:125], v[90:91] op_sel_hi:[1,0,1]
    v_cvt_pk_bf16_f32 v105, v90, v91
    v_pk_add_f32 v[4:5], v[92:93], v[32:33] op_sel_hi:[1,0] neg_lo:[0,1] neg_hi:[0,1]
    v_cvt_pk_bf16_f32 v4, v4, v5
    v_and_b32 v5, 0xffff0000, v4
    v_lshlrev_b32 v4, 16, v4
    v_pk_mul_f32 v[92:93], v[4:5], v[124:125] op_sel_hi:[1,0]
    v_pk_fma_f32 v[4:5], v[92:93], v[34:35], v[4:5] op_sel_hi:[1,0,1] neg_lo:[1,0,0] neg_hi:[1,0,0]
    v_pk_fma_f32 v[92:93], v[4:5], v[124:125], v[92:93] op_sel_hi:[1,0,1]
    v_cvt_pk_bf16_f32 v106, v92, v93
    v_pk_add_f32 v[4:5], v[94:95], v[32:33] op_sel_hi:[1,0] neg_lo:[0,1] neg_hi:[0,1]
    v_cvt_pk_bf16_f32 v4, v4, v5
    v_and_b32 v5, 0xffff0000, v4
    v_lshlrev_b32 v4, 16, v4
    v_pk_mul_f32 v[94:95], v[4:5], v[124:125] op_sel_hi:[1,0]
    v_pk_fma_f32 v[4:5], v[94:95], v[34:35], v[4:5] op_sel_hi:[1,0,1] neg_lo:[1,0,0] neg_hi:[1,0,0]
    v_pk_fma_f32 v[94:95], v[4:5], v[124:125], v[94:95] op_sel_hi:[1,0,1]
    v_cvt_pk_bf16_f32 v107, v94, v95
    buffer_store_dwordx4 v[104:107], v3, s[80:83], s18 offen offset:96
    v_pk_add_f32 v[4:5], v[96:97], v[36:37] op_sel_hi:[1,0] neg_lo:[0,1] neg_hi:[0,1]
    v_cvt_pk_bf16_f32 v4, v4, v5
    v_and_b32 v5, 0xffff0000, v4
    v_lshlrev_b32 v4, 16, v4
    v_pk_mul_f32 v[96:97], v[4:5], v[6:7] op_sel_hi:[1,0]
    v_pk_fma_f32 v[4:5], v[96:97], v[38:39], v[4:5] op_sel_hi:[1,0,1] neg_lo:[1,0,0] neg_hi:[1,0,0]
    v_pk_fma_f32 v[96:97], v[4:5], v[6:7], v[96:97] op_sel_hi:[1,0,1]
    v_cvt_pk_bf16_f32 v108, v96, v97
    v_pk_add_f32 v[4:5], v[98:99], v[36:37] op_sel_hi:[1,0] neg_lo:[0,1] neg_hi:[0,1]
    v_cvt_pk_bf16_f32 v4, v4, v5
    v_and_b32 v5, 0xffff0000, v4
    v_lshlrev_b32 v4, 16, v4
    v_pk_mul_f32 v[98:99], v[4:5], v[6:7] op_sel_hi:[1,0]
    v_pk_fma_f32 v[4:5], v[98:99], v[38:39], v[4:5] op_sel_hi:[1,0,1] neg_lo:[1,0,0] neg_hi:[1,0,0]
    v_pk_fma_f32 v[98:99], v[4:5], v[6:7], v[98:99] op_sel_hi:[1,0,1]
    v_cvt_pk_bf16_f32 v109, v98, v99
    v_pk_add_f32 v[4:5], v[100:101], v[36:37] op_sel_hi:[1,0] neg_lo:[0,1] neg_hi:[0,1]
    v_cvt_pk_bf16_f32 v4, v4, v5
    v_and_b32 v5, 0xffff0000, v4
    v_lshlrev_b32 v4, 16, v4
    v_pk_mul_f32 v[100:101], v[4:5], v[6:7] op_sel_hi:[1,0]
    v_pk_fma_f32 v[4:5], v[100:101], v[38:39], v[4:5] op_sel_hi:[1,0,1] neg_lo:[1,0,0] neg_hi:[1,0,0]
    v_pk_fma_f32 v[100:101], v[4:5], v[6:7], v[100:101] op_sel_hi:[1,0,1]
    v_cvt_pk_bf16_f32 v110, v100, v101
    v_pk_add_f32 v[4:5], v[102:103], v[36:37] op_sel_hi:[1,0] neg_lo:[0,1] neg_hi:[0,1]
    v_cvt_pk_bf16_f32 v4, v4, v5
    v_and_b32 v5, 0xffff0000, v4
    v_lshlrev_b32 v4, 16, v4
    v_pk_mul_f32 v[102:103], v[4:5], v[6:7] op_sel_hi:[1,0]
    v_pk_fma_f32 v[4:5], v[102:103], v[38:39], v[4:5] op_sel_hi:[1,0,1] neg_lo:[1,0,0] neg_hi:[1,0,0]
    v_pk_fma_f32 v[102:103], v[4:5], v[6:7], v[102:103] op_sel_hi:[1,0,1]
    v_cvt_pk_bf16_f32 v111, v102, v103
    buffer_store_dwordx4 v[108:111], v3, s[80:83], s18 offen offset:112
    s_endpgm
k1_shg:
    s_load_dwordx4 s[4:7], s[0:1], 64
    s_sub_u32 s16, s2, 576
    s_lshl_b32 s16, s16, 2
    s_add_u32 s16, s16, s3
    s_lshr_b32 s17, s16, 4
    s_lshr_b32 s18, s16, 3
    s_and_b32 s18, s18, 1
    s_and_b32 s19, s16, 7
    s_waitcnt lgkmcnt(0)
    s_mov_b32 s80, s14
    s_and_b32 s81, s15, 0xffff
    s_mov_b32 s82, 0x01b00000
    s_mov_b32 s83, 0x00020000
    s_cmp_eq_u32 s18, 0
    s_cselect_b32 s84, s4, s6
    s_cselect_b32 s85, s5, s7
    s_and_b32 s85, s85, 0xffff
    s_mov_b32 s86, 1835008
    s_mov_b32 s87, 0x00020000
    v_lshrrev_b32 v3, 5, v2
    v_mul_u32_u24 v3, 28672, v3
    v_and_b32 v4, 31, v2
    v_lshl_add_u32 v3, v4, 1, v3
    s_lshl_b32 s20, s17, 6
    v_add_u32 v3, s20, v3
    s_mul_i32 s20, s19, 229376
    buffer_load_ushort v10, v3, s[84:87], s20 offen
    s_add_u32 s20, s20, 3584
    buffer_load_ushort v11, v3, s[84:87], s20 offen
    s_add_u32 s20, s20, 3584
    buffer_load_ushort v12, v3, s[84:87], s20 offen
    s_add_u32 s20, s20, 3584
    buffer_load_ushort v13, v3, s[84:87], s20 offen
    s_add_u32 s20, s20, 3584
    buffer_load_ushort v14, v3, s[84:87], s20 offen
    s_add_u32 s20, s20, 3584
    buffer_load_ushort v15, v3, s[84:87], s20 offen
    s_add_u32 s20, s20, 3584
    buffer_load_ushort v16, v3, s[84:87], s20 offen
    s_add_u32 s20, s20, 3584
    buffer_load_ushort v17, v3, s[84:87], s20 offen
    s_add_u32 s20, s20, 3584
    s_add_u32 s20, s20, 28672
    buffer_load_ushort v18, v3, s[84:87], s20 offen
    s_add_u32 s20, s20, 3584
    buffer_load_ushort v19, v3, s[84:87], s20 offen
    s_add_u32 s20, s20, 3584
    buffer_load_ushort v20, v3, s[84:87], s20 offen
    s_add_u32 s20, s20, 3584
    buffer_load_ushort v21, v3, s[84:87], s20 offen
    s_add_u32 s20, s20, 3584
    buffer_load_ushort v22, v3, s[84:87], s20 offen
    s_add_u32 s20, s20, 3584
    buffer_load_ushort v23, v3, s[84:87], s20 offen
    s_add_u32 s20, s20, 3584
    buffer_load_ushort v24, v3, s[84:87], s20 offen
    s_add_u32 s20, s20, 3584
    buffer_load_ushort v25, v3, s[84:87], s20 offen
    s_add_u32 s20, s20, 3584
    s_add_u32 s20, s20, 28672
    buffer_load_ushort v26, v3, s[84:87], s20 offen
    s_add_u32 s20, s20, 3584
    buffer_load_ushort v27, v3, s[84:87], s20 offen
    s_add_u32 s20, s20, 3584
    buffer_load_ushort v28, v3, s[84:87], s20 offen
    s_add_u32 s20, s20, 3584
    buffer_load_ushort v29, v3, s[84:87], s20 offen
    s_add_u32 s20, s20, 3584
    buffer_load_ushort v30, v3, s[84:87], s20 offen
    s_add_u32 s20, s20, 3584
    buffer_load_ushort v31, v3, s[84:87], s20 offen
    s_add_u32 s20, s20, 3584
    buffer_load_ushort v32, v3, s[84:87], s20 offen
    s_add_u32 s20, s20, 3584
    buffer_load_ushort v33, v3, s[84:87], s20 offen
    s_add_u32 s20, s20, 3584
    s_add_u32 s20, s20, 28672
    buffer_load_ushort v34, v3, s[84:87], s20 offen
    s_add_u32 s20, s20, 3584
    buffer_load_ushort v35, v3, s[84:87], s20 offen
    s_add_u32 s20, s20, 3584
    buffer_load_ushort v36, v3, s[84:87], s20 offen
    s_add_u32 s20, s20, 3584
    buffer_load_ushort v37, v3, s[84:87], s20 offen
    s_add_u32 s20, s20, 3584
    buffer_load_ushort v38, v3, s[84:87], s20 offen
    s_add_u32 s20, s20, 3584
    buffer_load_ushort v39, v3, s[84:87], s20 offen
    s_add_u32 s20, s20, 3584
    buffer_load_ushort v40, v3, s[84:87], s20 offen
    s_add_u32 s20, s20, 3584
    buffer_load_ushort v41, v3, s[84:87], s20 offen
    s_add_u32 s20, s20, 3584
    s_add_u32 s20, s20, 28672
    s_lshl_b32 s20, s17, 1
    s_add_u32 s20, s20, s18
    s_lshl_b32 s20, s20, 15
    s_lshl_b32 s21, s19, 12
    s_add_u32 s20, s20, s21
    s_add_u32 s20, s20, 13107200
    v_lshlrev_b32 v4, 4, v2
    s_waitcnt vmcnt(24)
    v_lshl_or_b32 v50, v11, 16, v10
    v_lshl_or_b32 v51, v13, 16, v12
    v_lshl_or_b32 v52, v15, 16, v14
    v_lshl_or_b32 v53, v17, 16, v16
    buffer_store_dwordx4 v[50:53], v4, s[80:83], s20 offen offset:0
    s_waitcnt vmcnt(16)
    v_lshl_or_b32 v54, v19, 16, v18
    v_lshl_or_b32 v55, v21, 16, v20
    v_lshl_or_b32 v56, v23, 16, v22
    v_lshl_or_b32 v57, v25, 16, v24
    buffer_store_dwordx4 v[54:57], v4, s[80:83], s20 offen offset:1024
    s_waitcnt vmcnt(8)
    v_lshl_or_b32 v58, v27, 16, v26
    v_lshl_or_b32 v59, v29, 16, v28
    v_lshl_or_b32 v60, v31, 16, v30
    v_lshl_or_b32 v61, v33, 16, v32
    buffer_store_dwordx4 v[58:61], v4, s[80:83], s20 offen offset:2048
    s_waitcnt vmcnt(0)
    v_lshl_or_b32 v62, v35, 16, v34
    v_lshl_or_b32 v63, v37, 16, v36
    v_lshl_or_b32 v64, v39, 16, v38
    v_lshl_or_b32 v65, v41, 16, v40
    buffer_store_dwordx4 v[62:65], v4, s[80:83], s20 offen offset:3072
    s_endpgm
k1_end:
    s_endpgm
.text
.globl k2_kernel
.p2align 8
.type k2_kernel,@function
k2_kernel:
    s_cmp_ge_u32 s2, 512
    s_cbranch_scc1 k2_end
    s_load_dwordx2 s[14:15], s[0:1], 104
    v_lshrrev_b32 v1, 6, v0
    v_and_b32 v2, 63, v0
    v_readfirstlane_b32 s3, v1
    v_lshlrev_b32 v3, 4, v2
    s_waitcnt lgkmcnt(0)
    s_mov_b32 s80, s14
    s_and_b32 s81, s15, 0xffff
    s_mov_b32 s82, 0x01b00000
    s_mov_b32 s83, 0x00020000
    s_cmp_ge_u32 s2, 480
    s_cbranch_scc1 k2_shd
    s_cmp_ge_u32 s2, 256
    s_cbranch_scc1 k2_gemm
    s_setprio 1
    s_lshr_b32 s16, s3, 1
    s_and_b32 s17, s3, 1
    s_lshl_b32 s18, s2, 1
    s_add_u32 s18, s18, s16
    s_mul_i32 s20, s16, 21504
    s_lshl_b32 s21, s18, 12
    s_lshl_b32 s22, s17, 11
    s_add_u32 s21, s21, s22
    s_add_u32 s21, s21, 2097152
    buffer_load_dwordx4 v[40:43], v3, s[80:83], s21 offen
    buffer_load_dwordx4 v[44:47], v3, s[80:83], s21 offen offset:1024
    v_lshrrev_b32 v4, 5, v2
    v_lshlrev_b32 v4, 15, v4
    v_and_b32 v34, 31, v2
    v_lshl_add_u32 v4, v34, 4, v4
    s_lshr_b32 s22, s2, 2
    s_lshl_b32 s22, s22, 9
    s_and_b32 s23, s2, 3
    s_lshl_b32 s23, s23, 2
    s_add_u32 s22, s22, s23
    s_lshl_b32 s23, s3, 19
    s_add_u32 s22, s22, s23
    buffer_load_dword v128, v4, s[80:83], s22 offen
    s_add_u32 s22, s22, 65536
    buffer_load_dword v129, v4, s[80:83], s22 offen
    s_add_u32 s22, s22, 65536
    buffer_load_dword v130, v4, s[80:83], s22 offen
    s_add_u32 s22, s22, 65536
    buffer_load_dword v131, v4, s[80:83], s22 offen
    s_add_u32 s22, s22, 65536
    buffer_load_dword v132, v4, s[80:83], s22 offen
    s_add_u32 s22, s22, 65536
    buffer_load_dword v133, v4, s[80:83], s22 offen
    s_add_u32 s22, s22, 65536
    buffer_load_dword v134, v4, s[80:83], s22 offen
    s_add_u32 s22, s22, 65536
    buffer_load_dword v135, v4, s[80:83], s22 offen
    v_lshrrev_b32 v24, 5, v2
    v_mul_u32_u24 v24, 1536, v24
    v_lshl_add_u32 v24, v34, 4, v24
    s_mul_i32 s84, s17, 6144
    s_add_u32 s84, s84, s20
    s_add_u32 s84, s84, 9216
    v_add_u32 v24, s84, v24
    v_mov_b32 v28, 0
    v_mov_b32 v29, 0
    v_mov_b32 v30, 0
    v_mov_b32 v31, 0
    ds_write_b128 v24, v[28:31]
    ds_write_b128 v24, v[28:31] offset:3072
    v_lshlrev_b32 v25, 1, v2
    v_add_u32 v25, 4096, v25
    s_cmp_lg_u32 s3, 0
    s_cbranch_scc1 k2_cv_nozero
    v_cmp_gt_u32 vcc, 32, v2
    s_and_saveexec_b64 s[24:25], vcc
    ds_write_b16 v25, v28 offset:4160
    ds_write_b16 v25, v28 offset:25664
    v_cmp_gt_u32 vcc, 31, v2
    s_and_b64 exec, exec, vcc
    ds_write_b16 v25, v28 offset:2
    ds_write_b16 v25, v28 offset:21506
    s_mov_b64 exec, s[24:25]
k2_cv_nozero:
    s_lshl_b32 s84, s17, 4
    v_lshlrev_b32 v26, 5, v2
    v_add_u32 v26, s84, v26
    s_lshl_b32 s84, s16, 12
    s_add_u32 s84, s84, 43008
    v_add_u32 v20, 0, v26
    v_cvt_f32_u32 v20, v20
    v_cvt_pk_bf16_f32 v20, v20, v20
    v_lshlrev_b32 v20, 16, v20
    v_cvt_u32_f32 v20, v20
    v_lshrrev_b32 v21, 8, v20
    v_and_b32 v22, 7, v20
    v_lshrrev_b32 v23, 1, v20
    v_and_b32 v23, 0x7c, v23
    v_lshrrev_b32 v24, 1, v22
    v_add_u32 v24, 8, v24
    v_lshrrev_b32 v25, 2, v22
    v_lshl_add_u32 v25, v21, 1, v25
    v_add_u32 v25, 8, v25
    v_add_u32 v27, 12, v21
    v_cmp_le_u32 vcc, 1, v21
    v_add_u32 v23, s84, v23
    s_nop 0
    v_cndmask_b32 v22, v22, v24, vcc
    v_cmp_le_u32 vcc, 2, v21
    s_nop 1
    v_cndmask_b32 v22, v22, v25, vcc
    v_cmp_le_u32 vcc, 4, v21
    s_nop 1
    v_cndmask_b32 v22, v22, v27, vcc
    v_lshl_add_u32 v136, v22, 7, v23
    v_add_u32 v20, 1, v26
    v_cvt_f32_u32 v20, v20
    v_cvt_pk_bf16_f32 v20, v20, v20
    v_lshlrev_b32 v20, 16, v20
    v_cvt_u32_f32 v20, v20
    v_lshrrev_b32 v21, 8, v20
    v_and_b32 v22, 7, v20
    v_lshrrev_b32 v23, 1, v20
    v_and_b32 v23, 0x7c, v23
    v_lshrrev_b32 v24, 1, v22
    v_add_u32 v24, 8, v24
    v_lshrrev_b32 v25, 2, v22
    v_lshl_add_u32 v25, v21, 1, v25
    v_add_u32 v25, 8, v25
    v_add_u32 v27, 12, v21
    v_cmp_le_u32 vcc, 1, v21
    v_add_u32 v23, s84, v23
    s_nop 0
    v_cndmask_b32 v22, v22, v24, vcc
    v_cmp_le_u32 vcc, 2, v21
    s_nop 1
    v_cndmask_b32 v22, v22, v25, vcc
    v_cmp_le_u32 vcc, 4, v21
    s_nop 1
    v_cndmask_b32 v22, v22, v27, vcc
    v_lshl_add_u32 v137, v22, 7, v23
    v_add_u32 v20, 2, v26
    v_cvt_f32_u32 v20, v20
    v_cvt_pk_bf16_f32 v20, v20, v20
    v_lshlrev_b32 v20, 16, v20
    v_cvt_u32_f32 v20, v20
    v_lshrrev_b32 v21, 8, v20
    v_and_b32 v22, 7, v20
    v_lshrrev_b32 v23, 1, v20
    v_and_b32 v23, 0x7c, v23
    v_lshrrev_b32 v24, 1, v22
    v_add_u32 v24, 8, v24
    v_lshrrev_b32 v25, 2, v22
    v_lshl_add_u32 v25, v21, 1, v25
    v_add_u32 v25, 8, v25
    v_add_u32 v27, 12, v21
    v_cmp_le_u32 vcc, 1, v21
    v_add_u32 v23, s84, v23
    s_nop 0
    v_cndmask_b32 v22, v22, v24, vcc
    v_cmp_le_u32 vcc, 2, v21
    s_nop 1
    v_cndmask_b32 v22, v22, v25, vcc
    v_cmp_le_u32 vcc, 4, v21
    s_nop 1
    v_cndmask_b32 v22, v22, v27, vcc
    v_lshl_add_u32 v138, v22, 7, v23
    v_add_u32 v20, 3, v26
    v_cvt_f32_u32 v20, v20
    v_cvt_pk_bf16_f32 v20, v20, v20
    v_lshlrev_b32 v20, 16, v20
    v_cvt_u32_f32 v20, v20
    v_lshrrev_b32 v21, 8, v20
    v_and_b32 v22, 7, v20
    v_lshrrev_b32 v23, 1, v20
    v_and_b32 v23, 0x7c, v23
    v_lshrrev_b32 v24, 1, v22
    v_add_u32 v24, 8, v24
    v_lshrrev_b32 v25, 2, v22
    v_lshl_add_u32 v25, v21, 1, v25
    v_add_u32 v25, 8, v25
    v_add_u32 v27, 12, v21
    v_cmp_le_u32 vcc, 1, v21
    v_add_u32 v23, s84, v23
    s_nop 0
    v_cndmask_b32 v22, v22, v24, vcc
    v_cmp_le_u32 vcc, 2, v21
    s_nop 1
    v_cndmask_b32 v22, v22, v25, vcc
    v_cmp_le_u32 vcc, 4, v21
    s_nop 1
    v_cndmask_b32 v22, v22, v27, vcc
    v_lshl_add_u32 v139, v22, 7, v23
    v_add_u32 v20, 4, v26
    v_cvt_f32_u32 v20, v20
    v_cvt_pk_bf16_f32 v20, v20, v20
    v_lshlrev_b32 v20, 16, v20
    v_cvt_u32_f32 v20, v20
    v_lshrrev_b32 v21, 8, v20
    v_and_b32 v22, 7, v20
    v_lshrrev_b32 v23, 1, v20
    v_and_b32 v23, 0x7c, v23
    v_lshrrev_b32 v24, 1, v22
    v_add_u32 v24, 8, v24
    v_lshrrev_b32 v25, 2, v22
    v_lshl_add_u32 v25, v21, 1, v25
    v_add_u32 v25, 8, v25
    v_add_u32 v27, 12, v21
    v_cmp_le_u32 vcc, 1, v21
    v_add_u32 v23, s84, v23
    s_nop 0
    v_cndmask_b32 v22, v22, v24, vcc
    v_cmp_le_u32 vcc, 2, v21
    s_nop 1
    v_cndmask_b32 v22, v22, v25, vcc
    v_cmp_le_u32 vcc, 4, v21
    s_nop 1
    v_cndmask_b32 v22, v22, v27, vcc
    v_lshl_add_u32 v140, v22, 7, v23
    v_add_u32 v20, 5, v26
    v_cvt_f32_u32 v20, v20
    v_cvt_pk_bf16_f32 v20, v20, v20
    v_lshlrev_b32 v20, 16, v20
    v_cvt_u32_f32 v20, v20
    v_lshrrev_b32 v21, 8, v20
    v_and_b32 v22, 7, v20
    v_lshrrev_b32 v23, 1, v20
    v_and_b32 v23, 0x7c, v23
    v_lshrrev_b32 v24, 1, v22
    v_add_u32 v24, 8, v24
    v_lshrrev_b32 v25, 2, v22
    v_lshl_add_u32 v25, v21, 1, v25
    v_add_u32 v25, 8, v25
    v_add_u32 v27, 12, v21
    v_cmp_le_u32 vcc, 1, v21
    v_add_u32 v23, s84, v23
    s_nop 0
    v_cndmask_b32 v22, v22, v24, vcc
    v_cmp_le_u32 vcc, 2, v21
    s_nop 1
    v_cndmask_b32 v22, v22, v25, vcc
    v_cmp_le_u32 vcc, 4, v21
    s_nop 1
    v_cndmask_b32 v22, v22, v27, vcc
    v_lshl_add_u32 v141, v22, 7, v23
    v_add_u32 v20, 6, v26
    v_cvt_f32_u32 v20, v20
    v_cvt_pk_bf16_f32 v20, v20, v20
    v_lshlrev_b32 v20, 16, v20
    v_cvt_u32_f32 v20, v20
    v_lshrrev_b32 v21, 8, v20
    v_and_b32 v22, 7, v20
    v_lshrrev_b32 v23, 1, v20
    v_and_b32 v23, 0x7c, v23
    v_lshrrev_b32 v24, 1, v22
    v_add_u32 v24, 8, v24
    v_lshrrev_b32 v25, 2, v22
    v_lshl_add_u32 v25, v21, 1, v25
    v_add_u32 v25, 8, v25
    v_add_u32 v27, 12, v21
    v_cmp_le_u32 vcc, 1, v21
    v_add_u32 v23, s84, v23
    s_nop 0
    v_cndmask_b32 v22, v22, v24, vcc
    v_cmp_le_u32 vcc, 2, v21
    s_nop 1
    v_cndmask_b32 v22, v22, v25, vcc
    v_cmp_le_u32 vcc, 4, v21
    s_nop 1
    v_cndmask_b32 v22, v22, v27, vcc
    v_lshl_add_u32 v142, v22, 7, v23
    v_add_u32 v20, 7, v26
    v_cvt_f32_u32 v20, v20
    v_cvt_pk_bf16_f32 v20, v20, v20
    v_lshlrev_b32 v20, 16, v20
    v_cvt_u32_f32 v20, v20
    v_lshrrev_b32 v21, 8, v20
    v_and_b32 v22, 7, v20
    v_lshrrev_b32 v23, 1, v20
    v_and_b32 v23, 0x7c, v23
    v_lshrrev_b32 v24, 1, v22
    v_add_u32 v24, 8, v24
    v_lshrrev_b32 v25, 2, v22
    v_lshl_add_u32 v25, v21, 1, v25
    v_add_u32 v25, 8, v25
    v_add_u32 v27, 12, v21
    v_cmp_le_u32 vcc, 1, v21
    v_add_u32 v23, s84, v23
    s_nop 0
    v_cndmask_b32 v22, v22, v24, vcc
    v_cmp_le_u32 vcc, 2, v21
    s_nop 1
    v_cndmask_b32 v22, v22, v25, vcc
    v_cmp_le_u32 vcc, 4, v21
    s_nop 1
    v_cndmask_b32 v22, v22, v27, vcc
    v_lshl_add_u32 v143, v22, 7, v23
    v_add_u32 v20, 8, v26
    v_cvt_f32_u32 v20, v20
    v_cvt_pk_bf16_f32 v20, v20, v20
    v_lshlrev_b32 v20, 16, v20
    v_cvt_u32_f32 v20, v20
    v_lshrrev_b32 v21, 8, v20
    v_and_b32 v22, 7, v20
    v_lshrrev_b32 v23, 1, v20
    v_and_b32 v23, 0x7c, v23
    v_lshrrev_b32 v24, 1, v22
    v_add_u32 v24, 8, v24
    v_lshrrev_b32 v25, 2, v22
    v_lshl_add_u32 v25, v21, 1, v25
    v_add_u32 v25, 8, v25
    v_add_u32 v27, 12, v21
    v_cmp_le_u32 vcc, 1, v21
    v_add_u32 v23, s84, v23
    s_nop 0
    v_cndmask_b32 v22, v22, v24, vcc
    v_cmp_le_u32 vcc, 2, v21
    s_nop 1
    v_cndmask_b32 v22, v22, v25, vcc
    v_cmp_le_u32 vcc, 4, v21
    s_nop 1
    v_cndmask_b32 v22, v22, v27, vcc
    v_lshl_add_u32 v144, v22, 7, v23
    v_add_u32 v20, 9, v26
    v_cvt_f32_u32 v20, v20
    v_cvt_pk_bf16_f32 v20, v20, v20
    v_lshlrev_b32 v20, 16, v20
    v_cvt_u32_f32 v20, v20
    v_lshrrev_b32 v21, 8, v20
    v_and_b32 v22, 7, v20
    v_lshrrev_b32 v23, 1, v20
    v_and_b32 v23, 0x7c, v23
    v_lshrrev_b32 v24, 1, v22
    v_add_u32 v24, 8, v24
    v_lshrrev_b32 v25, 2, v22
    v_lshl_add_u32 v25, v21, 1, v25
    v_add_u32 v25, 8, v25
    v_add_u32 v27, 12, v21
    v_cmp_le_u32 vcc, 1, v21
    v_add_u32 v23, s84, v23
    s_nop 0
    v_cndmask_b32 v22, v22, v24, vcc
    v_cmp_le_u32 vcc, 2, v21
    s_nop 1
    v_cndmask_b32 v22, v22, v25, vcc
    v_cmp_le_u32 vcc, 4, v21
    s_nop 1
    v_cndmask_b32 v22, v22, v27, vcc
    v_lshl_add_u32 v145, v22, 7, v23
    v_add_u32 v20, 10, v26
    v_cvt_f32_u32 v20, v20
    v_cvt_pk_bf16_f32 v20, v20, v20
    v_lshlrev_b32 v20, 16, v20
    v_cvt_u32_f32 v20, v20
    v_lshrrev_b32 v21, 8, v20
    v_and_b32 v22, 7, v20
    v_lshrrev_b32 v23, 1, v20
    v_and_b32 v23, 0x7c, v23
    v_lshrrev_b32 v24, 1, v22
    v_add_u32 v24, 8, v24
    v_lshrrev_b32 v25, 2, v22
    v_lshl_add_u32 v25, v21, 1, v25
    v_add_u32 v25, 8, v25
    v_add_u32 v27, 12, v21
    v_cmp_le_u32 vcc, 1, v21
    v_add_u32 v23, s84, v23
    s_nop 0
    v_cndmask_b32 v22, v22, v24, vcc
    v_cmp_le_u32 vcc, 2, v21
    s_nop 1
    v_cndmask_b32 v22, v22, v25, vcc
    v_cmp_le_u32 vcc, 4, v21
    s_nop 1
    v_cndmask_b32 v22, v22, v27, vcc
    v_lshl_add_u32 v146, v22, 7, v23
    v_add_u32 v20, 11, v26
    v_cvt_f32_u32 v20, v20
    v_cvt_pk_bf16_f32 v20, v20, v20
    v_lshlrev_b32 v20, 16, v20
    v_cvt_u32_f32 v20, v20
    v_lshrrev_b32 v21, 8, v20
    v_and_b32 v22, 7, v20
    v_lshrrev_b32 v23, 1, v20
    v_and_b32 v23, 0x7c, v23
    v_lshrrev_b32 v24, 1, v22
    v_add_u32 v24, 8, v24
    v_lshrrev_b32 v25, 2, v22
    v_lshl_add_u32 v25, v21, 1, v25
    v_add_u32 v25, 8, v25
    v_add_u32 v27, 12, v21
    v_cmp_le_u32 vcc, 1, v21
    v_add_u32 v23, s84, v23
    s_nop 0
    v_cndmask_b32 v22, v22, v24, vcc
    v_cmp_le_u32 vcc, 2, v21
    s_nop 1
    v_cndmask_b32 v22, v22, v25, vcc
    v_cmp_le_u32 vcc, 4, v21
    s_nop 1
    v_cndmask_b32 v22, v22, v27, vcc
    v_lshl_add_u32 v147, v22, 7, v23
    v_add_u32 v20, 12, v26
    v_cvt_f32_u32 v20, v20
    v_cvt_pk_bf16_f32 v20, v20, v20
    v_lshlrev_b32 v20, 16, v20
    v_cvt_u32_f32 v20, v20
    v_lshrrev_b32 v21, 8, v20
    v_and_b32 v22, 7, v20
    v_lshrrev_b32 v23, 1, v20
    v_and_b32 v23, 0x7c, v23
    v_lshrrev_b32 v24, 1, v22
    v_add_u32 v24, 8, v24
    v_lshrrev_b32 v25, 2, v22
    v_lshl_add_u32 v25, v21, 1, v25
    v_add_u32 v25, 8, v25
    v_add_u32 v27, 12, v21
    v_cmp_le_u32 vcc, 1, v21
    v_add_u32 v23, s84, v23
    s_nop 0
    v_cndmask_b32 v22, v22, v24, vcc
    v_cmp_le_u32 vcc, 2, v21
    s_nop 1
    v_cndmask_b32 v22, v22, v25, vcc
    v_cmp_le_u32 vcc, 4, v21
    s_nop 1
    v_cndmask_b32 v22, v22, v27, vcc
    v_lshl_add_u32 v148, v22, 7, v23
    v_add_u32 v20, 13, v26
    v_cvt_f32_u32 v20, v20
    v_cvt_pk_bf16_f32 v20, v20, v20
    v_lshlrev_b32 v20, 16, v20
    v_cvt_u32_f32 v20, v20
    v_lshrrev_b32 v21, 8, v20
    v_and_b32 v22, 7, v20
    v_lshrrev_b32 v23, 1, v20
    v_and_b32 v23, 0x7c, v23
    v_lshrrev_b32 v24, 1, v22
    v_add_u32 v24, 8, v24
    v_lshrrev_b32 v25, 2, v22
    v_lshl_add_u32 v25, v21, 1, v25
    v_add_u32 v25, 8, v25
    v_add_u32 v27, 12, v21
    v_cmp_le_u32 vcc, 1, v21
    v_add_u32 v23, s84, v23
    s_nop 0
    v_cndmask_b32 v22, v22, v24, vcc
    v_cmp_le_u32 vcc, 2, v21
    s_nop 1
    v_cndmask_b32 v22, v22, v25, vcc
    v_cmp_le_u32 vcc, 4, v21
    s_nop 1
    v_cndmask_b32 v22, v22, v27, vcc
    v_lshl_add_u32 v149, v22, 7, v23
    v_add_u32 v20, 14, v26
    v_cvt_f32_u32 v20, v20
    v_cvt_pk_bf16_f32 v20, v20, v20
    v_lshlrev_b32 v20, 16, v20
    v_cvt_u32_f32 v20, v20
    v_lshrrev_b32 v21, 8, v20
    v_and_b32 v22, 7, v20
    v_lshrrev_b32 v23, 1, v20
    v_and_b32 v23, 0x7c, v23
    v_lshrrev_b32 v24, 1, v22
    v_add_u32 v24, 8, v24
    v_lshrrev_b32 v25, 2, v22
    v_lshl_add_u32 v25, v21, 1, v25
    v_add_u32 v25, 8, v25
    v_add_u32 v27, 12, v21
    v_cmp_le_u32 vcc, 1, v21
    v_add_u32 v23, s84, v23
    s_nop 0
    v_cndmask_b32 v22, v22, v24, vcc
    v_cmp_le_u32 vcc, 2, v21
    s_nop 1
    v_cndmask_b32 v22, v22, v25, vcc
    v_cmp_le_u32 vcc, 4, v21
    s_nop 1
    v_cndmask_b32 v22, v22, v27, vcc
    v_lshl_add_u32 v150, v22, 7, v23
    v_add_u32 v20, 15, v26
    v_cvt_f32_u32 v20, v20
    v_cvt_pk_bf16_f32 v20, v20, v20
    v_lshlrev_b32 v20, 16, v20
    v_cvt_u32_f32 v20, v20
    v_lshrrev_b32 v21, 8, v20
    v_and_b32 v22, 7, v20
    v_lshrrev_b32 v23, 1, v20
    v_and_b32 v23, 0x7c, v23
    v_lshrrev_b32 v24, 1, v22
    v_add_u32 v24, 8, v24
    v_lshrrev_b32 v25, 2, v22
    v_lshl_add_u32 v25, v21, 1, v25
    v_add_u32 v25, 8, v25
    v_add_u32 v27, 12, v21
    v_cmp_le_u32 vcc, 1, v21
    v_add_u32 v23, s84, v23
    s_nop 0
    v_cndmask_b32 v22, v22, v24, vcc
    v_cmp_le_u32 vcc, 2, v21
    s_nop 1
    v_cndmask_b32 v22, v22, v25, vcc
    v_cmp_le_u32 vcc, 4, v21
    s_nop 1
    v_cndmask_b32 v22, v22, v27, vcc
    v_lshl_add_u32 v151, v22, 7, v23
    v_lshrrev_b32 v20, 5, v2
    v_lshlrev_b32 v20, 3, v20
    v_sub_u32 v20, v20, v34
    v_lshlrev_b32 v20, 1, v20
    v_and_b32 v21, 1, v34
    v_mul_u32_u24 v21, 4158, v21
    v_add_u32 v20, v20, v21
    s_lshl_b32 s21, s17, 5
    s_add_u32 s21, s21, s20
    s_add_u32 s21, s21, 64
    v_add_u32 v152, s21, v20
    v_add_u32 v153, 1024, v152
    v_add_u32 v154, 2048, v152
    v_add_u32 v155, 3072, v152
    v_lshrrev_b32 v20, 5, v2
    v_mul_u32_u24 v20, 1536, v20
    v_lshl_add_u32 v20, v34, 4, v20
    s_mul_i32 s21, s17, 3072
    s_add_u32 s21, s21, s20
    s_add_u32 s21, s21, 8720
    v_add_u32 v156, s21, v20
    s_lshl_b32 s23, s3, 10
    s_sub_u32 s23, 3200, s23
    v_lshlrev_b32 v157, 1, v2
    v_sub_u32 v157, s23, v157
    v_lshrrev_b32 v158, 5, v2
    v_lshlrev_b32 v158, 9, v158
    v_lshl_add_u32 v158, v34, 2, v158
    s_lshl_b32 s84, s3, 11
    s_add_u32 s84, s84, 43008
    v_add_u32 v158, s84, v158
    s_mul_i32 s84, s17, 3072
    s_add_u32 s84, s84, s20
    s_add_u32 s84, s84, 9728
    v_add_u32 v159, s84, v3
    s_waitcnt vmcnt(8)
    ds_write_b32 v158, v40 offset:0
    ds_write_b32 v158, v41 offset:128
    ds_write_b32 v158, v42 offset:256
    ds_write_b32 v158, v43 offset:384
    ds_write_b32 v158, v44 offset:1024
    ds_write_b32 v158, v45 offset:1152
    ds_write_b32 v158, v46 offset:1280
    ds_write_b32 v158, v47 offset:1408
    s_waitcnt vmcnt(7)
    ds_write_b16 v157, v128 offset:896
    ds_write_b16 v157, v128 offset:5054
    ds_write_b16_d16_hi v157, v128 offset:22400
    ds_write_b16_d16_hi v157, v128 offset:26558
    s_waitcnt vmcnt(6)
    ds_write_b16 v157, v129 offset:768
    ds_write_b16 v157, v129 offset:4926
    ds_write_b16_d16_hi v157, v129 offset:22272
    ds_write_b16_d16_hi v157, v129 offset:26430
    s_waitcnt vmcnt(5)
    ds_write_b16 v157, v130 offset:640
    ds_write_b16 v157, v130 offset:4798
    ds_write_b16_d16_hi v157, v130 offset:22144
    ds_write_b16_d16_hi v157, v130 offset:26302
    s_waitcnt vmcnt(4)
    ds_write_b16 v157, v131 offset:512
    ds_write_b16 v157, v131 offset:4670
    ds_write_b16_d16_hi v157, v131 offset:22016
    ds_write_b16_d16_hi v157, v131 offset:26174
    s_waitcnt vmcnt(3)
    ds_write_b16 v157, v132 offset:384
    ds_write_b16 v157, v132 offset:4542
    ds_write_b16_d16_hi v157, v132 offset:21888
    ds_write_b16_d16_hi v157, v132 offset:26046
    s_waitcnt vmcnt(2)
    ds_write_b16 v157, v133 offset:256
    ds_write_b16 v157, v133 offset:4414
    ds_write_b16_d16_hi v157, v133 offset:21760
    ds_write_b16_d16_hi v157, v133 offset:25918
    s_waitcnt vmcnt(1)
    ds_write_b16 v157, v134 offset:128
    ds_write_b16 v157, v134 offset:4286
    ds_write_b16_d16_hi v157, v134 offset:21632
    ds_write_b16_d16_hi v157, v134 offset:25790
    s_waitcnt vmcnt(0)
    ds_write_b16 v157, v135 offset:0
    ds_write_b16 v157, v135 offset:4158
    ds_write_b16_d16_hi v157, v135 offset:21504
    ds_write_b16_d16_hi v157, v135 offset:25662
    s_waitcnt lgkmcnt(0)
    s_barrier
    ds_read_b32 v40, v136
    ds_read_b32 v42, v137
    ds_read_b32 v44, v138
    ds_read_b32 v46, v139
    ds_read_b32 v48, v140
    ds_read_b32 v50, v141
    ds_read_b32 v52, v142
    ds_read_b32 v54, v143
    ds_read_b32 v56, v144
    ds_read_b32 v58, v145
    ds_read_b32 v60, v146
    ds_read_b32 v62, v147
    ds_read_b32 v64, v148
    ds_read_b32 v66, v149
    ds_read_b32 v68, v150
    ds_read_b32 v70, v151
    v_mov_b32 v160, 0
    v_mov_b32 v161, 0
    v_mov_b32 v162, 0
    v_mov_b32 v163, 0
    v_mov_b32 v164, 0
    v_mov_b32 v165, 0
    v_mov_b32 v166, 0
    v_mov_b32 v167, 0
    v_mov_b32 v168, 0
    v_mov_b32 v169, 0
    v_mov_b32 v170, 0
    v_mov_b32 v171, 0
    v_mov_b32 v172, 0
    v_mov_b32 v173, 0
    v_mov_b32 v174, 0
    v_mov_b32 v175, 0
    v_mov_b32 v176, 0
    v_mov_b32 v177, 0
    v_mov_b32 v178, 0
    v_mov_b32 v179, 0
    v_mov_b32 v180, 0
    v_mov_b32 v181, 0
    v_mov_b32 v182, 0
    v_mov_b32 v183, 0
    v_mov_b32 v184, 0
    v_mov_b32 v185, 0
    v_mov_b32 v186, 0
    v_mov_b32 v187, 0
    v_mov_b32 v188, 0
    v_mov_b32 v189, 0
    v_mov_b32 v190, 0
    v_mov_b32 v191, 0
    s_waitcnt lgkmcnt(0)
    v_cvt_pk_bf16_f32 v20, v40, v42
    v_lshlrev_b32 v12, 16, v20
    v_and_b32 v13, 0xffff0000, v20
    v_sub_f32 v12, v40, v12
    v_sub_f32 v13, v42, v13
    v_cvt_pk_bf16_f32 v24, v12, v13
    v_cvt_pk_bf16_f32 v21, v44, v46
    v_lshlrev_b32 v12, 16, v21
    v_and_b32 v13, 0xffff0000, v21
    v_sub_f32 v12, v44, v12
    v_sub_f32 v13, v46, v13
    v_cvt_pk_bf16_f32 v25, v12, v13
    v_cvt_pk_bf16_f32 v22, v48, v50
    v_lshlrev_b32 v12, 16, v22
    v_and_b32 v13, 0xffff0000, v22
    v_sub_f32 v12, v48, v12
    v_sub_f32 v13, v50, v13
    v_cvt_pk_bf16_f32 v26, v12, v13
    v_cvt_pk_bf16_f32 v23, v52, v54
    v_lshlrev_b32 v12, 16, v23
    v_and_b32 v13, 0xffff0000, v23
    v_sub_f32 v12, v52, v12
    v_sub_f32 v13, v54, v13
    v_cvt_pk_bf16_f32 v27, v12, v13
    ds_write_b128 v159, v[20:23] offset:0
    ds_write_b128 v159, v[24:27] offset:6144
    v_cvt_pk_bf16_f32 v28, v56, v58
    v_lshlrev_b32 v12, 16, v28
    v_and_b32 v13, 0xffff0000, v28
    v_sub_f32 v12, v56, v12
    v_sub_f32 v13, v58, v13
    v_cvt_pk_bf16_f32 v32, v12, v13
    v_cvt_pk_bf16_f32 v29, v60, v62
    v_lshlrev_b32 v12, 16, v29
    v_and_b32 v13, 0xffff0000, v29
    v_sub_f32 v12, v60, v12
    v_sub_f32 v13, v62, v13
    v_cvt_pk_bf16_f32 v33, v12, v13
    v_cvt_pk_bf16_f32 v30, v64, v66
    v_lshlrev_b32 v12, 16, v30
    v_and_b32 v13, 0xffff0000, v30
    v_sub_f32 v12, v64, v12
    v_sub_f32 v13, v66, v13
    v_cvt_pk_bf16_f32 v34, v12, v13
    v_cvt_pk_bf16_f32 v31, v68, v70
    v_lshlrev_b32 v12, 16, v31
    v_and_b32 v13, 0xffff0000, v31
    v_sub_f32 v12, v68, v12
    v_sub_f32 v13, v70, v13
    v_cvt_pk_bf16_f32 v35, v12, v13
    ds_write_b128 v159, v[28:31] offset:1536
    ds_write_b128 v159, v[32:35] offset:7680
    s_waitcnt lgkmcnt(0)
    s_barrier
    s_setprio 1
    ds_read2_b32 v[64:65], v155 offset0:240 offset1:241
    ds_read2_b32 v[66:67], v155 offset0:242 offset1:243
    ds_read_b128 v[76:79], v156 offset:1520
    ds_read_b128 v[80:83], v156 offset:7664
    ds_read_b128 v[68:71], v156 offset:1008
    ds_read_b128 v[72:75], v156 offset:7152
    ds_read2_b32 v[84:85], v155 offset0:224 offset1:225
    ds_read2_b32 v[86:87], v155 offset0:226 offset1:227
    ds_read_b128 v[96:99], v156 offset:1504
    ds_read_b128 v[100:103], v156 offset:7648
    ds_read_b128 v[88:91], v156 offset:992
    ds_read_b128 v[92:95], v156 offset:7136
    ds_read2_b32 v[104:105], v155 offset0:208 offset1:209
    ds_read2_b32 v[106:107], v155 offset0:210 offset1:211
    ds_read_b128 v[116:119], v156 offset:1488
    ds_read_b128 v[120:123], v156 offset:7632
    ds_read_b128 v[108:111], v156 offset:976
    ds_read_b128 v[112:115], v156 offset:7120
    s_waitcnt lgkmcnt(12)
    v_mfma_f32_32x32x16_bf16 v[176:191], v[64:67], v[76:79], v[176:191]
    v_mfma_f32_32x32x16_bf16 v[176:191], v[64:67], v[80:83], v[176:191]
    v_mfma_f32_32x32x16_bf16 v[160:175], v[64:67], v[68:71], v[160:175]
    v_mfma_f32_32x32x16_bf16 v[160:175], v[64:67], v[72:75], v[160:175]
    ds_read2_b32 v[64:65], v155 offset0:192 offset1:193
    ds_read2_b32 v[66:67], v155 offset0:194 offset1:195
    ds_read_b128 v[76:79], v156 offset:1472
    ds_read_b128 v[80:83], v156 offset:7616
    ds_read_b128 v[68:71], v156 offset:960
    ds_read_b128 v[72:75], v156 offset:7104
    s_waitcnt lgkmcnt(12)
    v_mfma_f32_32x32x16_bf16 v[176:191], v[84:87], v[96:99], v[176:191]
    v_mfma_f32_32x32x16_bf16 v[176:191], v[84:87], v[100:103], v[176:191]
    v_mfma_f32_32x32x16_bf16 v[160:175], v[84:87], v[88:91], v[160:175]
    v_mfma_f32_32x32x16_bf16 v[160:175], v[84:87], v[92:95], v[160:175]
    ds_read2_b32 v[84:85], v155 offset0:176 offset1:177
    ds_read2_b32 v[86:87], v155 offset0:178 offset1:179
    ds_read_b128 v[96:99], v156 offset:1456
    ds_read_b128 v[100:103], v156 offset:7600
    ds_read_b128 v[88:91], v156 offset:944
    ds_read_b128 v[92:95], v156 offset:7088
    s_waitcnt lgkmcnt(12)
    v_mfma_f32_32x32x16_bf16 v[176:191], v[104:107], v[116:119], v[176:191]
    v_mfma_f32_32x32x16_bf16 v[176:191], v[104:107], v[120:123], v[176:191]
    v_mfma_f32_32x32x16_bf16 v[160:175], v[104:107], v[108:111], v[160:175]
    v_mfma_f32_32x32x16_bf16 v[160:175], v[104:107], v[112:115], v[160:175]
    ds_read2_b32 v[104:105], v155 offset0:160 offset1:161
    ds_read2_b32 v[106:107], v155 offset0:162 offset1:163
    ds_read_b128 v[116:119], v156 offset:1440
    ds_read_b128 v[120:123], v156 offset:7584
    ds_read_b128 v[108:111], v156 offset:928
    ds_read_b128 v[112:115], v156 offset:7072
    s_waitcnt lgkmcnt(12)
    v_mfma_f32_32x32x16_bf16 v[176:191], v[64:67], v[76:79], v[176:191]
    v_mfma_f32_32x32x16_bf16 v[176:191], v[64:67], v[80:83], v[176:191]
    v_mfma_f32_32x32x16_bf16 v[160:175], v[64:67], v[68:71], v[160:175]
    v_mfma_f32_32x32x16_bf16 v[160:175], v[64:67], v[72:75], v[160:175]
    ds_read2_b32 v[64:65], v155 offset0:144 offset1:145
    ds_read2_b32 v[66:67], v155 offset0:146 offset1:147
    ds_read_b128 v[76:79], v156 offset:1424
    ds_read_b128 v[80:83], v156 offset:7568
    ds_read_b128 v[68:71], v156 offset:912
    ds_read_b128 v[72:75], v156 offset:7056
    s_waitcnt lgkmcnt(12)
    v_mfma_f32_32x32x16_bf16 v[176:191], v[84:87], v[96:99], v[176:191]
    v_mfma_f32_32x32x16_bf16 v[176:191], v[84:87], v[100:103], v[176:191]
    v_mfma_f32_32x32x16_bf16 v[160:175], v[84:87], v[88:91], v[160:175]
    v_mfma_f32_32x32x16_bf16 v[160:175], v[84:87], v[92:95], v[160:175]
    ds_read2_b32 v[84:85], v155 offset0:128 offset1:129
    ds_read2_b32 v[86:87], v155 offset0:130 offset1:131
    ds_read_b128 v[96:99], v156 offset:1408
    ds_read_b128 v[100:103], v156 offset:7552
    ds_read_b128 v[88:91], v156 offset:896
    ds_read_b128 v[92:95], v156 offset:7040
    s_waitcnt lgkmcnt(12)
    v_mfma_f32_32x32x16_bf16 v[176:191], v[104:107], v[116:119], v[176:191]
    v_mfma_f32_32x32x16_bf16 v[176:191], v[104:107], v[120:123], v[176:191]
    v_mfma_f32_32x32x16_bf16 v[160:175], v[104:107], v[108:111], v[160:175]
    v_mfma_f32_32x32x16_bf16 v[160:175], v[104:107], v[112:115], v[160:175]
    ds_read2_b32 v[104:105], v155 offset0:112 offset1:113
    ds_read2_b32 v[106:107], v155 offset0:114 offset1:115
    ds_read_b128 v[116:119], v156 offset:1392
    ds_read_b128 v[120:123], v156 offset:7536
    ds_read_b128 v[108:111], v156 offset:880
    ds_read_b128 v[112:115], v156 offset:7024
    s_waitcnt lgkmcnt(12)
    v_mfma_f32_32x32x16_bf16 v[176:191], v[64:67], v[76:79], v[176:191]
    v_mfma_f32_32x32x16_bf16 v[176:191], v[64:67], v[80:83], v[176:191]
    v_mfma_f32_32x32x16_bf16 v[160:175], v[64:67], v[68:71], v[160:175]
    v_mfma_f32_32x32x16_bf16 v[160:175], v[64:67], v[72:75], v[160:175]
    ds_read2_b32 v[64:65], v155 offset0:96 offset1:97
    ds_read2_b32 v[66:67], v155 offset0:98 offset1:99
    ds_read_b128 v[76:79], v156 offset:1376
    ds_read_b128 v[80:83], v156 offset:7520
    ds_read_b128 v[68:71], v156 offset:864
    ds_read_b128 v[72:75], v156 offset:7008
    s_waitcnt lgkmcnt(12)
    v_mfma_f32_32x32x16_bf16 v[176:191], v[84:87], v[96:99], v[176:191]
    v_mfma_f32_32x32x16_bf16 v[176:191], v[84:87], v[100:103], v[176:191]
    v_mfma_f32_32x32x16_bf16 v[160:175], v[84:87], v[88:91], v[160:175]
    v_mfma_f32_32x32x16_bf16 v[160:175], v[84:87], v[92:95], v[160:175]
    ds_read2_b32 v[84:85], v155 offset0:80 offset1:81
    ds_read2_b32 v[86:87], v155 offset0:82 offset1:83
    ds_read_b128 v[96:99], v156 offset:1360
    ds_read_b128 v[100:103], v156 offset:7504
    ds_read_b128 v[88:91], v156 offset:848
    ds_read_b128 v[92:95], v156 offset:6992
    s_waitcnt lgkmcnt(12)
    v_mfma_f32_32x32x16_bf16 v[176:191], v[104:107], v[116:119], v[176:191]
    v_mfma_f32_32x32x16_bf16 v[176:191], v[104:107], v[120:123], v[176:191]
    v_mfma_f32_32x32x16_bf16 v[160:175], v[104:107], v[108:111], v[160:175]
    v_mfma_f32_32x32x16_bf16 v[160:175], v[104:107], v[112:115], v[160:175]
    ds_read2_b32 v[104:105], v155 offset0:64 offset1:65
    ds_read2_b32 v[106:107], v155 offset0:66 offset1:67
    ds_read_b128 v[116:119], v156 offset:1344
    ds_read_b128 v[120:123], v156 offset:7488
    ds_read_b128 v[108:111], v156 offset:832
    ds_read_b128 v[112:115], v156 offset:6976
    s_waitcnt lgkmcnt(12)
    v_mfma_f32_32x32x16_bf16 v[176:191], v[64:67], v[76:79], v[176:191]
    v_mfma_f32_32x32x16_bf16 v[176:191], v[64:67], v[80:83], v[176:191]
    v_mfma_f32_32x32x16_bf16 v[160:175], v[64:67], v[68:71], v[160:175]
    v_mfma_f32_32x32x16_bf16 v[160:175], v[64:67], v[72:75], v[160:175]
    ds_read2_b32 v[64:65], v155 offset0:48 offset1:49
    ds_read2_b32 v[66:67], v155 offset0:50 offset1:51
    ds_read_b128 v[76:79], v156 offset:1328
    ds_read_b128 v[80:83], v156 offset:7472
    ds_read_b128 v[68:71], v156 offset:816
    ds_read_b128 v[72:75], v156 offset:6960
    s_waitcnt lgkmcnt(12)
    v_mfma_f32_32x32x16_bf16 v[176:191], v[84:87], v[96:99], v[176:191]
    v_mfma_f32_32x32x16_bf16 v[176:191], v[84:87], v[100:103], v[176:191]
    v_mfma_f32_32x32x16_bf16 v[160:175], v[84:87], v[88:91], v[160:175]
    v_mfma_f32_32x32x16_bf16 v[160:175], v[84:87], v[92:95], v[160:175]
    ds_read2_b32 v[84:85], v155 offset0:32 offset1:33
    ds_read2_b32 v[86:87], v155 offset0:34 offset1:35
    ds_read_b128 v[96:99], v156 offset:1312
    ds_read_b128 v[100:103], v156 offset:7456
    ds_read_b128 v[88:91], v156 offset:800
    ds_read_b128 v[92:95], v156 offset:6944
    s_waitcnt lgkmcnt(12)
    v_mfma_f32_32x32x16_bf16 v[176:191], v[104:107], v[116:119], v[176:191]
    v_mfma_f32_32x32x16_bf16 v[176:191], v[104:107], v[120:123], v[176:191]
    v_mfma_f32_32x32x16_bf16 v[160:175], v[104:107], v[108:111], v[160:175]
    v_mfma_f32_32x32x16_bf16 v[160:175], v[104:107], v[112:115], v[160:175]
    ds_read2_b32 v[104:105], v155 offset0:16 offset1:17
    ds_read2_b32 v[106:107], v155 offset0:18 offset1:19
    ds_read_b128 v[116:119], v156 offset:1296
    ds_read_b128 v[120:123], v156 offset:7440
    ds_read_b128 v[108:111], v156 offset:784
    ds_read_b128 v[112:115], v156 offset:6928
    s_waitcnt lgkmcnt(12)
    v_mfma_f32_32x32x16_bf16 v[176:191], v[64:67], v[76:79], v[176:191]
    v_mfma_f32_32x32x16_bf16 v[176:191], v[64:67], v[80:83], v[176:191]
    v_mfma_f32_32x32x16_bf16 v[160:175], v[64:67], v[68:71], v[160:175]
    v_mfma_f32_32x32x16_bf16 v[160:175], v[64:67], v[72:75], v[160:175]
    ds_read2_b32 v[64:65], v155 offset0:0 offset1:1
    ds_read2_b32 v[66:67], v155 offset0:2 offset1:3
    ds_read_b128 v[76:79], v156 offset:1280
    ds_read_b128 v[80:83], v156 offset:7424
    ds_read_b128 v[68:71], v156 offset:768
    ds_read_b128 v[72:75], v156 offset:6912
    s_waitcnt lgkmcnt(12)
    v_mfma_f32_32x32x16_bf16 v[176:191], v[84:87], v[96:99], v[176:191]
    v_mfma_f32_32x32x16_bf16 v[176:191], v[84:87], v[100:103], v[176:191]
    v_mfma_f32_32x32x16_bf16 v[160:175], v[84:87], v[88:91], v[160:175]
    v_mfma_f32_32x32x16_bf16 v[160:175], v[84:87], v[92:95], v[160:175]
    ds_read2_b32 v[84:85], v154 offset0:240 offset1:241
    ds_read2_b32 v[86:87], v154 offset0:242 offset1:243
    ds_read_b128 v[96:99], v156 offset:1264
    ds_read_b128 v[100:103], v156 offset:7408
    ds_read_b128 v[88:91], v156 offset:752
    ds_read_b128 v[92:95], v156 offset:6896
    s_waitcnt lgkmcnt(12)
    v_mfma_f32_32x32x16_bf16 v[176:191], v[104:107], v[116:119], v[176:191]
    v_mfma_f32_32x32x16_bf16 v[176:191], v[104:107], v[120:123], v[176:191]
    v_mfma_f32_32x32x16_bf16 v[160:175], v[104:107], v[108:111], v[160:175]
    v_mfma_f32_32x32x16_bf16 v[160:175], v[104:107], v[112:115], v[160:175]
    ds_read2_b32 v[104:105], v154 offset0:224 offset1:225
    ds_read2_b32 v[106:107], v154 offset0:226 offset1:227
    ds_read_b128 v[116:119], v156 offset:1248
    ds_read_b128 v[120:123], v156 offset:7392
    ds_read_b128 v[108:111], v156 offset:736
    ds_read_b128 v[112:115], v156 offset:6880
    s_waitcnt lgkmcnt(12)
    v_mfma_f32_32x32x16_bf16 v[176:191], v[64:67], v[76:79], v[176:191]
    v_mfma_f32_32x32x16_bf16 v[176:191], v[64:67], v[80:83], v[176:191]
    v_mfma_f32_32x32x16_bf16 v[160:175], v[64:67], v[68:71], v[160:175]
    v_mfma_f32_32x32x16_bf16 v[160:175], v[64:67], v[72:75], v[160:175]
    ds_read2_b32 v[64:65], v154 offset0:208 offset1:209
    ds_read2_b32 v[66:67], v154 offset0:210 offset1:211
    ds_read_b128 v[76:79], v156 offset:1232
    ds_read_b128 v[80:83], v156 offset:7376
    ds_read_b128 v[68:71], v156 offset:720
    ds_read_b128 v[72:75], v156 offset:6864
    s_waitcnt lgkmcnt(12)
    v_mfma_f32_32x32x16_bf16 v[176:191], v[84:87], v[96:99], v[176:191]
    v_mfma_f32_32x32x16_bf16 v[176:191], v[84:87], v[100:103], v[176:191]
    v_mfma_f32_32x32x16_bf16 v[160:175], v[84:87], v[88:91], v[160:175]
    v_mfma_f32_32x32x16_bf16 v[160:175], v[84:87], v[92:95], v[160:175]
    ds_read2_b32 v[84:85], v154 offset0:192 offset1:193
    ds_read2_b32 v[86:87], v154 offset0:194 offset1:195
    ds_read_b128 v[96:99], v156 offset:1216
    ds_read_b128 v[100:103], v156 offset:7360
    ds_read_b128 v[88:91], v156 offset:704
    ds_read_b128 v[92:95], v156 offset:6848
    s_waitcnt lgkmcnt(12)
    v_mfma_f32_32x32x16_bf16 v[176:191], v[104:107], v[116:119], v[176:191]
    v_mfma_f32_32x32x16_bf16 v[176:191], v[104:107], v[120:123], v[176:191]
    v_mfma_f32_32x32x16_bf16 v[160:175], v[104:107], v[108:111], v[160:175]
    v_mfma_f32_32x32x16_bf16 v[160:175], v[104:107], v[112:115], v[160:175]
    ds_read2_b32 v[104:105], v154 offset0:176 offset1:177
    ds_read2_b32 v[106:107], v154 offset0:178 offset1:179
    ds_read_b128 v[116:119], v156 offset:1200
    ds_read_b128 v[120:123], v156 offset:7344
    ds_read_b128 v[108:111], v156 offset:688
    ds_read_b128 v[112:115], v156 offset:6832
    s_waitcnt lgkmcnt(12)
    v_mfma_f32_32x32x16_bf16 v[176:191], v[64:67], v[76:79], v[176:191]
    v_mfma_f32_32x32x16_bf16 v[176:191], v[64:67], v[80:83], v[176:191]
    v_mfma_f32_32x32x16_bf16 v[160:175], v[64:67], v[68:71], v[160:175]
    v_mfma_f32_32x32x16_bf16 v[160:175], v[64:67], v[72:75], v[160:175]
    ds_read2_b32 v[64:65], v154 offset0:160 offset1:161
    ds_read2_b32 v[66:67], v154 offset0:162 offset1:163
    ds_read_b128 v[76:79], v156 offset:1184
    ds_read_b128 v[80:83], v156 offset:7328
    ds_read_b128 v[68:71], v156 offset:672
    ds_read_b128 v[72:75], v156 offset:6816
    s_waitcnt lgkmcnt(12)
    v_mfma_f32_32x32x16_bf16 v[176:191], v[84:87], v[96:99], v[176:191]
    v_mfma_f32_32x32x16_bf16 v[176:191], v[84:87], v[100:103], v[176:191]
    v_mfma_f32_32x32x16_bf16 v[160:175], v[84:87], v[88:91], v[160:175]
    v_mfma_f32_32x32x16_bf16 v[160:175], v[84:87], v[92:95], v[160:175]
    ds_read2_b32 v[84:85], v154 offset0:144 offset1:145
    ds_read2_b32 v[86:87], v154 offset0:146 offset1:147
    ds_read_b128 v[96:99], v156 offset:1168
    ds_read_b128 v[100:103], v156 offset:7312
    ds_read_b128 v[88:91], v156 offset:656
    ds_read_b128 v[92:95], v156 offset:6800
    s_waitcnt lgkmcnt(12)
    v_mfma_f32_32x32x16_bf16 v[176:191], v[104:107], v[116:119], v[176:191]
    v_mfma_f32_32x32x16_bf16 v[176:191], v[104:107], v[120:123], v[176:191]
    v_mfma_f32_32x32x16_bf16 v[160:175], v[104:107], v[108:111], v[160:175]
    v_mfma_f32_32x32x16_bf16 v[160:175], v[104:107], v[112:115], v[160:175]
    ds_read2_b32 v[104:105], v154 offset0:128 offset1:129
    ds_read2_b32 v[106:107], v154 offset0:130 offset1:131
    ds_read_b128 v[116:119], v156 offset:1152
    ds_read_b128 v[120:123], v156 offset:7296
    ds_read_b128 v[108:111], v156 offset:640
    ds_read_b128 v[112:115], v156 offset:6784
    s_waitcnt lgkmcnt(12)
    v_mfma_f32_32x32x16_bf16 v[176:191], v[64:67], v[76:79], v[176:191]
    v_mfma_f32_32x32x16_bf16 v[176:191], v[64:67], v[80:83], v[176:191]
    v_mfma_f32_32x32x16_bf16 v[160:175], v[64:67], v[68:71], v[160:175]
    v_mfma_f32_32x32x16_bf16 v[160:175], v[64:67], v[72:75], v[160:175]
    ds_read2_b32 v[64:65], v154 offset0:112 offset1:113
    ds_read2_b32 v[66:67], v154 offset0:114 offset1:115
    ds_read_b128 v[76:79], v156 offset:1136
    ds_read_b128 v[80:83], v156 offset:7280
    ds_read_b128 v[68:71], v156 offset:624
    ds_read_b128 v[72:75], v156 offset:6768
    s_waitcnt lgkmcnt(12)
    v_mfma_f32_32x32x16_bf16 v[176:191], v[84:87], v[96:99], v[176:191]
    v_mfma_f32_32x32x16_bf16 v[176:191], v[84:87], v[100:103], v[176:191]
    v_mfma_f32_32x32x16_bf16 v[160:175], v[84:87], v[88:91], v[160:175]
    v_mfma_f32_32x32x16_bf16 v[160:175], v[84:87], v[92:95], v[160:175]
    ds_read2_b32 v[84:85], v154 offset0:96 offset1:97
    ds_read2_b32 v[86:87], v154 offset0:98 offset1:99
    ds_read_b128 v[96:99], v156 offset:1120
    ds_read_b128 v[100:103], v156 offset:7264
    ds_read_b128 v[88:91], v156 offset:608
    ds_read_b128 v[92:95], v156 offset:6752
    s_waitcnt lgkmcnt(12)
    v_mfma_f32_32x32x16_bf16 v[176:191], v[104:107], v[116:119], v[176:191]
    v_mfma_f32_32x32x16_bf16 v[176:191], v[104:107], v[120:123], v[176:191]
    v_mfma_f32_32x32x16_bf16 v[160:175], v[104:107], v[108:111], v[160:175]
    v_mfma_f32_32x32x16_bf16 v[160:175], v[104:107], v[112:115], v[160:175]
    ds_read2_b32 v[104:105], v154 offset0:80 offset1:81
    ds_read2_b32 v[106:107], v154 offset0:82 offset1:83
    ds_read_b128 v[116:119], v156 offset:1104
    ds_read_b128 v[120:123], v156 offset:7248
    ds_read_b128 v[108:111], v156 offset:592
    ds_read_b128 v[112:115], v156 offset:6736
    s_waitcnt lgkmcnt(12)
    v_mfma_f32_32x32x16_bf16 v[176:191], v[64:67], v[76:79], v[176:191]
    v_mfma_f32_32x32x16_bf16 v[176:191], v[64:67], v[80:83], v[176:191]
    v_mfma_f32_32x32x16_bf16 v[160:175], v[64:67], v[68:71], v[160:175]
    v_mfma_f32_32x32x16_bf16 v[160:175], v[64:67], v[72:75], v[160:175]
    ds_read2_b32 v[64:65], v154 offset0:64 offset1:65
    ds_read2_b32 v[66:67], v154 offset0:66 offset1:67
    ds_read_b128 v[76:79], v156 offset:1088
    ds_read_b128 v[80:83], v156 offset:7232
    ds_read_b128 v[68:71], v156 offset:576
    ds_read_b128 v[72:75], v156 offset:6720
    s_waitcnt lgkmcnt(12)
    v_mfma_f32_32x32x16_bf16 v[176:191], v[84:87], v[96:99], v[176:191]
    v_mfma_f32_32x32x16_bf16 v[176:191], v[84:87], v[100:103], v[176:191]
    v_mfma_f32_32x32x16_bf16 v[160:175], v[84:87], v[88:91], v[160:175]
    v_mfma_f32_32x32x16_bf16 v[160:175], v[84:87], v[92:95], v[160:175]
    ds_read2_b32 v[84:85], v154 offset0:48 offset1:49
    ds_read2_b32 v[86:87], v154 offset0:50 offset1:51
    ds_read_b128 v[96:99], v156 offset:1072
    ds_read_b128 v[100:103], v156 offset:7216
    ds_read_b128 v[88:91], v156 offset:560
    ds_read_b128 v[92:95], v156 offset:6704
    s_waitcnt lgkmcnt(12)
    v_mfma_f32_32x32x16_bf16 v[176:191], v[104:107], v[116:119], v[176:191]
    v_mfma_f32_32x32x16_bf16 v[176:191], v[104:107], v[120:123], v[176:191]
    v_mfma_f32_32x32x16_bf16 v[160:175], v[104:107], v[108:111], v[160:175]
    v_mfma_f32_32x32x16_bf16 v[160:175], v[104:107], v[112:115], v[160:175]
    ds_read2_b32 v[104:105], v154 offset0:32 offset1:33
    ds_read2_b32 v[106:107], v154 offset0:34 offset1:35
    ds_read_b128 v[116:119], v156 offset:1056
    ds_read_b128 v[120:123], v156 offset:7200
    ds_read_b128 v[108:111], v156 offset:544
    ds_read_b128 v[112:115], v156 offset:6688
    s_waitcnt lgkmcnt(12)
    v_mfma_f32_32x32x16_bf16 v[176:191], v[64:67], v[76:79], v[176:191]
    v_mfma_f32_32x32x16_bf16 v[176:191], v[64:67], v[80:83], v[176:191]
    v_mfma_f32_32x32x16_bf16 v[160:175], v[64:67], v[68:71], v[160:175]
    v_mfma_f32_32x32x16_bf16 v[160:175], v[64:67], v[72:75], v[160:175]
    ds_read2_b32 v[64:65], v154 offset0:16 offset1:17
    ds_read2_b32 v[66:67], v154 offset0:18 offset1:19
    ds_read_b128 v[76:79], v156 offset:1040
    ds_read_b128 v[80:83], v156 offset:7184
    ds_read_b128 v[68:71], v156 offset:528
    ds_read_b128 v[72:75], v156 offset:6672
    s_waitcnt lgkmcnt(12)
    v_mfma_f32_32x32x16_bf16 v[176:191], v[84:87], v[96:99], v[176:191]
    v_mfma_f32_32x32x16_bf16 v[176:191], v[84:87], v[100:103], v[176:191]
    v_mfma_f32_32x32x16_bf16 v[160:175], v[84:87], v[88:91], v[160:175]
    v_mfma_f32_32x32x16_bf16 v[160:175], v[84:87], v[92:95], v[160:175]
    ds_read2_b32 v[84:85], v154 offset0:0 offset1:1
    ds_read2_b32 v[86:87], v154 offset0:2 offset1:3
    ds_read_b128 v[96:99], v156 offset:1024
    ds_read_b128 v[100:103], v156 offset:7168
    ds_read_b128 v[88:91], v156 offset:512
    ds_read_b128 v[92:95], v156 offset:6656
    s_waitcnt lgkmcnt(12)
    v_mfma_f32_32x32x16_bf16 v[176:191], v[104:107], v[116:119], v[176:191]
    v_mfma_f32_32x32x16_bf16 v[176:191], v[104:107], v[120:123], v[176:191]
    v_mfma_f32_32x32x16_bf16 v[160:175], v[104:107], v[108:111], v[160:175]
    v_mfma_f32_32x32x16_bf16 v[160:175], v[104:107], v[112:115], v[160:175]
    ds_read2_b32 v[104:105], v153 offset0:240 offset1:241
    ds_read2_b32 v[106:107], v153 offset0:242 offset1:243
    ds_read_b128 v[116:119], v156 offset:1008
    ds_read_b128 v[120:123], v156 offset:7152
    s_waitcnt lgkmcnt(10)
    v_mfma_f32_32x32x16_bf16 v[176:191], v[64:67], v[76:79], v[176:191]
    v_mfma_f32_32x32x16_bf16 v[176:191], v[64:67], v[80:83], v[176:191]
    v_mfma_f32_32x32x16_bf16 v[160:175], v[64:67], v[68:71], v[160:175]
    v_mfma_f32_32x32x16_bf16 v[160:175], v[64:67], v[72:75], v[160:175]
    ds_read2_b32 v[64:65], v153 offset0:224 offset1:225
    ds_read2_b32 v[66:67], v153 offset0:226 offset1:227
    ds_read_b128 v[76:79], v156 offset:992
    ds_read_b128 v[80:83], v156 offset:7136
    s_waitcnt lgkmcnt(8)
    v_mfma_f32_32x32x16_bf16 v[176:191], v[84:87], v[96:99], v[176:191]
    v_mfma_f32_32x32x16_bf16 v[176:191], v[84:87], v[100:103], v[176:191]
    v_mfma_f32_32x32x16_bf16 v[160:175], v[84:87], v[88:91], v[160:175]
    v_mfma_f32_32x32x16_bf16 v[160:175], v[84:87], v[92:95], v[160:175]
    ds_read2_b32 v[84:85], v153 offset0:208 offset1:209
    ds_read2_b32 v[86:87], v153 offset0:210 offset1:211
    ds_read_b128 v[96:99], v156 offset:976
    ds_read_b128 v[100:103], v156 offset:7120
    s_waitcnt lgkmcnt(8)
    v_mfma_f32_32x32x16_bf16 v[176:191], v[104:107], v[116:119], v[176:191]
    v_mfma_f32_32x32x16_bf16 v[176:191], v[104:107], v[120:123], v[176:191]
    ds_read2_b32 v[104:105], v153 offset0:192 offset1:193
    ds_read2_b32 v[106:107], v153 offset0:194 offset1:195
    ds_read_b128 v[116:119], v156 offset:960
    ds_read_b128 v[120:123], v156 offset:7104
    s_waitcnt lgkmcnt(8)
    v_mfma_f32_32x32x16_bf16 v[176:191], v[64:67], v[76:79], v[176:191]
    v_mfma_f32_32x32x16_bf16 v[176:191], v[64:67], v[80:83], v[176:191]
    ds_read2_b32 v[64:65], v153 offset0:176 offset1:177
    ds_read2_b32 v[66:67], v153 offset0:178 offset1:179
    ds_read_b128 v[76:79], v156 offset:944
    ds_read_b128 v[80:83], v156 offset:7088
    s_waitcnt lgkmcnt(8)
    v_mfma_f32_32x32x16_bf16 v[176:191], v[84:87], v[96:99], v[176:191]
    v_mfma_f32_32x32x16_bf16 v[176:191], v[84:87], v[100:103], v[176:191]
    ds_read2_b32 v[84:85], v153 offset0:160 offset1:161
    ds_read2_b32 v[86:87], v153 offset0:162 offset1:163
    ds_read_b128 v[96:99], v156 offset:928
    ds_read_b128 v[100:103], v156 offset:7072
    s_waitcnt lgkmcnt(8)
    v_mfma_f32_32x32x16_bf16 v[176:191], v[104:107], v[116:119], v[176:191]
    v_mfma_f32_32x32x16_bf16 v[176:191], v[104:107], v[120:123], v[176:191]
    ds_read2_b32 v[104:105], v153 offset0:144 offset1:145
    ds_read2_b32 v[106:107], v153 offset0:146 offset1:147
    ds_read_b128 v[116:119], v156 offset:912
    ds_read_b128 v[120:123], v156 offset:7056
    s_waitcnt lgkmcnt(8)
    v_mfma_f32_32x32x16_bf16 v[176:191], v[64:67], v[76:79], v[176:191]
    v_mfma_f32_32x32x16_bf16 v[176:191], v[64:67], v[80:83], v[176:191]
    ds_read2_b32 v[64:65], v153 offset0:128 offset1:129
    ds_read2_b32 v[66:67], v153 offset0:130 offset1:131
    ds_read_b128 v[76:79], v156 offset:896
    ds_read_b128 v[80:83], v156 offset:7040
    s_waitcnt lgkmcnt(8)
    v_mfma_f32_32x32x16_bf16 v[176:191], v[84:87], v[96:99], v[176:191]
    v_mfma_f32_32x32x16_bf16 v[176:191], v[84:87], v[100:103], v[176:191]
    ds_read2_b32 v[84:85], v153 offset0:112 offset1:113
    ds_read2_b32 v[86:87], v153 offset0:114 offset1:115
    ds_read_b128 v[96:99], v156 offset:880
    ds_read_b128 v[100:103], v156 offset:7024
    s_waitcnt lgkmcnt(8)
    v_mfma_f32_32x32x16_bf16 v[176:191], v[104:107], v[116:119], v[176:191]
    v_mfma_f32_32x32x16_bf16 v[176:191], v[104:107], v[120:123], v[176:191]
    ds_read2_b32 v[104:105], v153 offset0:96 offset1:97
    ds_read2_b32 v[106:107], v153 offset0:98 offset1:99
    ds_read_b128 v[116:119], v156 offset:864
    ds_read_b128 v[120:123], v156 offset:7008
    s_waitcnt lgkmcnt(8)
    v_mfma_f32_32x32x16_bf16 v[176:191], v[64:67], v[76:79], v[176:191]
    v_mfma_f32_32x32x16_bf16 v[176:191], v[64:67], v[80:83], v[176:191]
    ds_read2_b32 v[64:65], v153 offset0:80 offset1:81
    ds_read2_b32 v[66:67], v153 offset0:82 offset1:83
    ds_read_b128 v[76:79], v156 offset:848
    ds_read_b128 v[80:83], v156 offset:6992
    s_waitcnt lgkmcnt(8)
    v_mfma_f32_32x32x16_bf16 v[176:191], v[84:87], v[96:99], v[176:191]
    v_mfma_f32_32x32x16_bf16 v[176:191], v[84:87], v[100:103], v[176:191]
    ds_read2_b32 v[84:85], v153 offset0:64 offset1:65
    ds_read2_b32 v[86:87], v153 offset0:66 offset1:67
    ds_read_b128 v[96:99], v156 offset:832
    ds_read_b128 v[100:103], v156 offset:6976
    s_waitcnt lgkmcnt(8)
    v_mfma_f32_32x32x16_bf16 v[176:191], v[104:107], v[116:119], v[176:191]
    v_mfma_f32_32x32x16_bf16 v[176:191], v[104:107], v[120:123], v[176:191]
    ds_read2_b32 v[104:105], v153 offset0:48 offset1:49
    ds_read2_b32 v[106:107], v153 offset0:50 offset1:51
    ds_read_b128 v[116:119], v156 offset:816
    ds_read_b128 v[120:123], v156 offset:6960
    s_waitcnt lgkmcnt(8)
    v_mfma_f32_32x32x16_bf16 v[176:191], v[64:67], v[76:79], v[176:191]
    v_mfma_f32_32x32x16_bf16 v[176:191], v[64:67], v[80:83], v[176:191]
    ds_read2_b32 v[64:65], v153 offset0:32 offset1:33
    ds_read2_b32 v[66:67], v153 offset0:34 offset1:35
    ds_read_b128 v[76:79], v156 offset:800
    ds_read_b128 v[80:83], v156 offset:6944
    s_waitcnt lgkmcnt(8)
    v_mfma_f32_32x32x16_bf16 v[176:191], v[84:87], v[96:99], v[176:191]
    v_mfma_f32_32x32x16_bf16 v[176:191], v[84:87], v[100:103], v[176:191]
    ds_read2_b32 v[84:85], v153 offset0:16 offset1:17
    ds_read2_b32 v[86:87], v153 offset0:18 offset1:19
    ds_read_b128 v[96:99], v156 offset:784
    ds_read_b128 v[100:103], v156 offset:6928
    s_waitcnt lgkmcnt(8)
    v_mfma_f32_32x32x16_bf16 v[176:191], v[104:107], v[116:119], v[176:191]
    v_mfma_f32_32x32x16_bf16 v[176:191], v[104:107], v[120:123], v[176:191]
    ds_read2_b32 v[104:105], v153 offset0:0 offset1:1
    ds_read2_b32 v[106:107], v153 offset0:2 offset1:3
    ds_read_b128 v[116:119], v156 offset:768
    ds_read_b128 v[120:123], v156 offset:6912
    s_waitcnt lgkmcnt(8)
    v_mfma_f32_32x32x16_bf16 v[176:191], v[64:67], v[76:79], v[176:191]
    v_mfma_f32_32x32x16_bf16 v[176:191], v[64:67], v[80:83], v[176:191]
    ds_read2_b32 v[64:65], v152 offset0:240 offset1:241
    ds_read2_b32 v[66:67], v152 offset0:242 offset1:243
    ds_read_b128 v[76:79], v156 offset:752
    ds_read_b128 v[80:83], v156 offset:6896
    s_waitcnt lgkmcnt(8)
    v_mfma_f32_32x32x16_bf16 v[176:191], v[84:87], v[96:99], v[176:191]
    v_mfma_f32_32x32x16_bf16 v[176:191], v[84:87], v[100:103], v[176:191]
    ds_read2_b32 v[84:85], v152 offset0:224 offset1:225
    ds_read2_b32 v[86:87], v152 offset0:226 offset1:227
    ds_read_b128 v[96:99], v156 offset:736
    ds_read_b128 v[100:103], v156 offset:6880
    s_waitcnt lgkmcnt(8)
    v_mfma_f32_32x32x16_bf16 v[176:191], v[104:107], v[116:119], v[176:191]
    v_mfma_f32_32x32x16_bf16 v[176:191], v[104:107], v[120:123], v[176:191]
    ds_read2_b32 v[104:105], v152 offset0:208 offset1:209
    ds_read2_b32 v[106:107], v152 offset0:210 offset1:211
    ds_read_b128 v[116:119], v156 offset:720
    ds_read_b128 v[120:123], v156 offset:6864
    s_waitcnt lgkmcnt(8)
    v_mfma_f32_32x32x16_bf16 v[176:191], v[64:67], v[76:79], v[176:191]
    v_mfma_f32_32x32x16_bf16 v[176:191], v[64:67], v[80:83], v[176:191]
    ds_read2_b32 v[64:65], v152 offset0:192 offset1:193
    ds_read2_b32 v[66:67], v152 offset0:194 offset1:195
    ds_read_b128 v[76:79], v156 offset:704
    ds_read_b128 v[80:83], v156 offset:6848
    s_waitcnt lgkmcnt(8)
    v_mfma_f32_32x32x16_bf16 v[176:191], v[84:87], v[96:99], v[176:191]
    v_mfma_f32_32x32x16_bf16 v[176:191], v[84:87], v[100:103], v[176:191]
    ds_read2_b32 v[84:85], v152 offset0:176 offset1:177
    ds_read2_b32 v[86:87], v152 offset0:178 offset1:179
    ds_read_b128 v[96:99], v156 offset:688
    ds_read_b128 v[100:103], v156 offset:6832
    s_waitcnt lgkmcnt(8)
    v_mfma_f32_32x32x16_bf16 v[176:191], v[104:107], v[116:119], v[176:191]
    v_mfma_f32_32x32x16_bf16 v[176:191], v[104:107], v[120:123], v[176:191]
    ds_read2_b32 v[104:105], v152 offset0:160 offset1:161
    ds_read2_b32 v[106:107], v152 offset0:162 offset1:163
    ds_read_b128 v[116:119], v156 offset:672
    ds_read_b128 v[120:123], v156 offset:6816
    s_waitcnt lgkmcnt(8)
    v_mfma_f32_32x32x16_bf16 v[176:191], v[64:67], v[76:79], v[176:191]
    v_mfma_f32_32x32x16_bf16 v[176:191], v[64:67], v[80:83], v[176:191]
    ds_read2_b32 v[64:65], v152 offset0:144 offset1:145
    ds_read2_b32 v[66:67], v152 offset0:146 offset1:147
    ds_read_b128 v[76:79], v156 offset:656
    ds_read_b128 v[80:83], v156 offset:6800
    s_waitcnt lgkmcnt(8)
    v_mfma_f32_32x32x16_bf16 v[176:191], v[84:87], v[96:99], v[176:191]
    v_mfma_f32_32x32x16_bf16 v[176:191], v[84:87], v[100:103], v[176:191]
    ds_read2_b32 v[84:85], v152 offset0:128 offset1:129
    ds_read2_b32 v[86:87], v152 offset0:130 offset1:131
    ds_read_b128 v[96:99], v156 offset:640
    ds_read_b128 v[100:103], v156 offset:6784
    s_waitcnt lgkmcnt(8)
    v_mfma_f32_32x32x16_bf16 v[176:191], v[104:107], v[116:119], v[176:191]
    v_mfma_f32_32x32x16_bf16 v[176:191], v[104:107], v[120:123], v[176:191]
    ds_read2_b32 v[104:105], v152 offset0:112 offset1:113
    ds_read2_b32 v[106:107], v152 offset0:114 offset1:115
    ds_read_b128 v[116:119], v156 offset:624
    ds_read_b128 v[120:123], v156 offset:6768
    s_waitcnt lgkmcnt(8)
    v_mfma_f32_32x32x16_bf16 v[176:191], v[64:67], v[76:79], v[176:191]
    v_mfma_f32_32x32x16_bf16 v[176:191], v[64:67], v[80:83], v[176:191]
    ds_read2_b32 v[64:65], v152 offset0:96 offset1:97
    ds_read2_b32 v[66:67], v152 offset0:98 offset1:99
    ds_read_b128 v[76:79], v156 offset:608
    ds_read_b128 v[80:83], v156 offset:6752
    s_waitcnt lgkmcnt(8)
    v_mfma_f32_32x32x16_bf16 v[176:191], v[84:87], v[96:99], v[176:191]
    v_mfma_f32_32x32x16_bf16 v[176:191], v[84:87], v[100:103], v[176:191]
    ds_read2_b32 v[84:85], v152 offset0:80 offset1:81
    ds_read2_b32 v[86:87], v152 offset0:82 offset1:83
    ds_read_b128 v[96:99], v156 offset:592
    ds_read_b128 v[100:103], v156 offset:6736
    s_waitcnt lgkmcnt(8)
    v_mfma_f32_32x32x16_bf16 v[176:191], v[104:107], v[116:119], v[176:191]
    v_mfma_f32_32x32x16_bf16 v[176:191], v[104:107], v[120:123], v[176:191]
    ds_read2_b32 v[104:105], v152 offset0:64 offset1:65
    ds_read2_b32 v[106:107], v152 offset0:66 offset1:67
    ds_read_b128 v[116:119], v156 offset:576
    ds_read_b128 v[120:123], v156 offset:6720
    s_waitcnt lgkmcnt(8)
    v_mfma_f32_32x32x16_bf16 v[176:191], v[64:67], v[76:79], v[176:191]
    v_mfma_f32_32x32x16_bf16 v[176:191], v[64:67], v[80:83], v[176:191]
    ds_read2_b32 v[64:65], v152 offset0:48 offset1:49
    ds_read2_b32 v[66:67], v152 offset0:50 offset1:51
    ds_read_b128 v[76:79], v156 offset:560
    ds_read_b128 v[80:83], v156 offset:6704
    s_waitcnt lgkmcnt(8)
    v_mfma_f32_32x32x16_bf16 v[176:191], v[84:87], v[96:99], v[176:191]
    v_mfma_f32_32x32x16_bf16 v[176:191], v[84:87], v[100:103], v[176:191]
    ds_read2_b32 v[84:85], v152 offset0:32 offset1:33
    ds_read2_b32 v[86:87], v152 offset0:34 offset1:35
    ds_read_b128 v[96:99], v156 offset:544
    ds_read_b128 v[100:103], v156 offset:6688
    s_waitcnt lgkmcnt(8)
    v_mfma_f32_32x32x16_bf16 v[176:191], v[104:107], v[116:119], v[176:191]
    v_mfma_f32_32x32x16_bf16 v[176:191], v[104:107], v[120:123], v[176:191]
    ds_read2_b32 v[104:105], v152 offset0:16 offset1:17
    ds_read2_b32 v[106:107], v152 offset0:18 offset1:19
    ds_read_b128 v[116:119], v156 offset:528
    ds_read_b128 v[120:123], v156 offset:6672
    s_waitcnt lgkmcnt(8)
    v_mfma_f32_32x32x16_bf16 v[176:191], v[64:67], v[76:79], v[176:191]
    v_mfma_f32_32x32x16_bf16 v[176:191], v[64:67], v[80:83], v[176:191]
    ds_read2_b32 v[64:65], v152 offset0:0 offset1:1
    ds_read2_b32 v[66:67], v152 offset0:2 offset1:3
    ds_read_b128 v[76:79], v156 offset:512
    ds_read_b128 v[80:83], v156 offset:6656
    s_waitcnt lgkmcnt(8)
    v_mfma_f32_32x32x16_bf16 v[176:191], v[84:87], v[96:99], v[176:191]
    v_mfma_f32_32x32x16_bf16 v[176:191], v[84:87], v[100:103], v[176:191]
    s_waitcnt lgkmcnt(4)
    v_mfma_f32_32x32x16_bf16 v[176:191], v[104:107], v[116:119], v[176:191]
    v_mfma_f32_32x32x16_bf16 v[176:191], v[104:107], v[120:123], v[176:191]
    s_waitcnt lgkmcnt(0)
    v_mfma_f32_32x32x16_bf16 v[176:191], v[64:67], v[76:79], v[176:191]
    v_mfma_f32_32x32x16_bf16 v[176:191], v[64:67], v[80:83], v[176:191]
    s_nop 7
    s_nop 3
    v_and_b32 v4, 31, v2
    v_mov_b32 v64, v160
    v_mov_b32 v65, v161
    v_mov_b32 v66, v162
    v_mov_b32 v67, v163
    v_mov_b32 v68, v164
    v_mov_b32 v69, v165
    v_mov_b32 v70, v166
    v_mov_b32 v71, v167
    v_mov_b32 v72, v168
    v_mov_b32 v73, v169
    v_mov_b32 v74, v170
    v_mov_b32 v75, v171
    v_mov_b32 v76, v172
    v_mov_b32 v77, v173
    v_mov_b32 v78, v174
    v_mov_b32 v79, v175
    v_mov_b32 v80, v176
    v_mov_b32 v81, v177
    v_mov_b32 v82, v178
    v_mov_b32 v83, v179
    v_mov_b32 v84, v180
    v_mov_b32 v85, v181
    v_mov_b32 v86, v182
    v_mov_b32 v87, v183
    v_mov_b32 v88, v184
    v_mov_b32 v89, v185
    v_mov_b32 v90, v186
    v_mov_b32 v91, v187
    v_mov_b32 v92, v188
    v_mov_b32 v93, v189
    v_mov_b32 v94, v190
    v_mov_b32 v95, v191
    s_lshl_b32 s21, s3, 12
    s_add_u32 s21, s21, 43008
    v_add_u32 v5, s21, v3
    s_xor_b32 s21, s3, 1
    s_lshl_b32 s21, s21, 12
    s_add_u32 s21, s21, 43008
    v_add_u32 v6, s21, v3
    s_nop 7
    s_cmp_eq_u32 s17, 0
    s_cbranch_scc1 k2_cv_sp0
    ds_write_b128 v5, v[64:67] offset:0
    ds_write_b128 v5, v[68:71] offset:1024
    ds_write_b128 v5, v[72:75] offset:2048
    ds_write_b128 v5, v[76:79] offset:3072
    s_nop 1
    v_mov_b32 v64, v80
    v_mov_b32 v65, v81
    v_mov_b32 v66, v82
    v_mov_b32 v67, v83
    v_mov_b32 v68, v84
    v_mov_b32 v69, v85
    v_mov_b32 v70, v86
    v_mov_b32 v71, v87
    v_mov_b32 v72, v88
    v_mov_b32 v73, v89
    v_mov_b32 v74, v90
    v_mov_b32 v75, v91
    v_mov_b32 v76, v92
    v_mov_b32 v77, v93
    v_mov_b32 v78, v94
    v_mov_b32 v79, v95
    s_branch k2_cv_join
k2_cv_sp0:
    ds_write_b128 v5, v[80:83] offset:0
    ds_write_b128 v5, v[84:87] offset:1024
    ds_write_b128 v5, v[88:91] offset:2048
    ds_write_b128 v5, v[92:95] offset:3072
k2_cv_join:
    s_waitcnt lgkmcnt(0)
    s_barrier
    ds_read_b128 v[100:103], v6 offset:0
    ds_read_b128 v[104:107], v6 offset:1024
    ds_read_b128 v[108:111], v6 offset:2048
    ds_read_b128 v[112:115], v6 offset:3072
    v_lshlrev_b32 v5, 6, v4
    v_lshrrev_b32 v7, 5, v2
    v_lshl_add_u32 v5, v7, 3, v5
    s_lshl_b32 s21, s18, 12
    s_lshl_b32 s22, s17, 11
    s_add_u32 s21, s21, s22
    s_add_u32 s21, s21, 26214400
    s_waitcnt lgkmcnt(0)
    v_add_f32 v64, v64, v100
    v_add_f32 v65, v65, v101
    v_add_f32 v66, v66, v102
    v_add_f32 v67, v67, v103
    v_cvt_pk_bf16_f32 v120, v64, v65
    v_cvt_pk_bf16_f32 v121, v66, v67
    buffer_store_dwordx2 v[120:121], v5, s[80:83], s21 offen offset:0
    v_add_f32 v68, v68, v104
    v_add_f32 v69, v69, v105
    v_add_f32 v70, v70, v106
    v_add_f32 v71, v71, v107
    v_cvt_pk_bf16_f32 v122, v68, v69
    v_cvt_pk_bf16_f32 v123, v70, v71
    buffer_store_dwordx2 v[122:123], v5, s[80:83], s21 offen offset:16
    v_add_f32 v72, v72, v108
    v_add_f32 v73, v73, v109
    v_add_f32 v74, v74, v110
    v_add_f32 v75, v75, v111
    v_cvt_pk_bf16_f32 v124, v72, v73
    v_cvt_pk_bf16_f32 v125, v74, v75
    buffer_store_dwordx2 v[124:125], v5, s[80:83], s21 offen offset:32
    v_add_f32 v76, v76, v112
    v_add_f32 v77, v77, v113
    v_add_f32 v78, v78, v114
    v_add_f32 v79, v79, v115
    v_cvt_pk_bf16_f32 v126, v76, v77
    v_cvt_pk_bf16_f32 v127, v78, v79
    buffer_store_dwordx2 v[126:127], v5, s[80:83], s21 offen offset:48
    s_endpgm
k2_gemm:
    s_setprio 3
    s_sub_u32 s16, s2, 256
    s_and_b32 s17, s16, 15
    s_lshr_b32 s18, s16, 4
    s_lshl_b32 s19, s18, 2
    s_add_u32 s19, s19, s3
    s_lshl_b32 s20, s17, 2
    s_add_u32 s21, s20, s3
    s_lshl_b32 s22, s19, 16
    s_add_u32 s22, s22, 13107200
    s_add_u32 s23, s22, 32768
    s_lshl_b32 s24, s21, 15
    s_add_u32 s24, s24, 0
    s_mul_i32 s25, s3, 3072
    v_add_u32 v4, s25, v3
    v_add_u32 v5, 36864, v4
    v_add_u32 v6, 36864, v3
    s_add_u32 s26, s25, 0
    s_mov_b32 m0, s26
    s_add_u32 s26, s26, 1024
    buffer_load_dwordx4 v3, s[80:83], s22 offen lds
    s_add_u32 s22, s22, 1024
    s_mov_b32 m0, s26
    s_add_u32 s26, s26, 1024
    buffer_load_dwordx4 v3, s[80:83], s23 offen lds
    s_add_u32 s23, s23, 1024
    s_mov_b32 m0, s26
    s_nop 0
    buffer_load_dwordx4 v3, s[80:83], s24 offen lds
    s_add_u32 s24, s24, 1024
    s_add_u32 s26, s25, 12288
    s_mov_b32 m0, s26
    s_add_u32 s26, s26, 1024
    buffer_load_dwordx4 v3, s[80:83], s22 offen lds
    s_add_u32 s22, s22, 1024
    s_mov_b32 m0, s26
    s_add_u32 s26, s26, 1024
    buffer_load_dwordx4 v3, s[80:83], s23 offen lds
    s_add_u32 s23, s23, 1024
    s_mov_b32 m0, s26
    s_nop 0
    buffer_load_dwordx4 v3, s[80:83], s24 offen lds
    s_add_u32 s24, s24, 1024
    s_add_u32 s26, s25, 24576
    s_mov_b32 m0, s26
    s_add_u32 s26, s26, 1024
    buffer_load_dwordx4 v3, s[80:83], s22 offen lds
    s_add_u32 s22, s22, 1024
    s_mov_b32 m0, s26
    s_add_u32 s26, s26, 1024
    buffer_load_dwordx4 v3, s[80:83], s23 offen lds
    s_add_u32 s23, s23, 1024
    s_mov_b32 m0, s26
    s_nop 0
    buffer_load_dwordx4 v3, s[80:83], s24 offen lds
    s_add_u32 s24, s24, 1024
    s_add_u32 s26, s25, 36864
    s_mov_b32 m0, s26
    s_add_u32 s26, s26, 1024
    buffer_load_dwordx4 v3, s[80:83], s22 offen lds
    s_add_u32 s22, s22, 1024
    s_mov_b32 m0, s26
    s_add_u32 s26, s26, 1024
    buffer_load_dwordx4 v3, s[80:83], s23 offen lds
    s_add_u32 s23, s23, 1024
    s_mov_b32 m0, s26
    s_nop 0
    buffer_load_dwordx4 v3, s[80:83], s24 offen lds
    s_add_u32 s24, s24, 1024
    s_add_u32 s26, s25, 49152
    s_mov_b32 m0, s26
    s_add_u32 s26, s26, 1024
    buffer_load_dwordx4 v3, s[80:83], s22 offen lds
    s_add_u32 s22, s22, 1024
    s_mov_b32 m0, s26
    s_add_u32 s26, s26, 1024
    buffer_load_dwordx4 v3, s[80:83], s23 offen lds
    s_add_u32 s23, s23, 1024
    s_mov_b32 m0, s26
    s_nop 0
    buffer_load_dwordx4 v3, s[80:83], s24 offen lds
    s_add_u32 s24, s24, 1024
    v_mov_b32 v128, 0
    v_mov_b32 v129, 0
    v_mov_b32 v130, 0
    v_mov_b32 v131, 0
    v_mov_b32 v132, 0
    v_mov_b32 v133, 0
    v_mov_b32 v134, 0
    v_mov_b32 v135, 0
    v_mov_b32 v136, 0
    v_mov_b32 v137, 0
    v_mov_b32 v138, 0
    v_mov_b32 v139, 0
    v_mov_b32 v140, 0
    v_mov_b32 v141, 0
    v_mov_b32 v142, 0
    v_mov_b32 v143, 0
    v_mov_b32 v144, 0
    v_mov_b32 v145, 0
    v_mov_b32 v146, 0
    v_mov_b32 v147, 0
    v_mov_b32 v148, 0
    v_mov_b32 v149, 0
    v_mov_b32 v150, 0
    v_mov_b32 v151, 0
    v_mov_b32 v152, 0
    v_mov_b32 v153, 0
    v_mov_b32 v154, 0
    v_mov_b32 v155, 0
    v_mov_b32 v156, 0
    v_mov_b32 v157, 0
    v_mov_b32 v158, 0
    v_mov_b32 v159, 0
    v_mov_b32 v160, 0
    v_mov_b32 v161, 0
    v_mov_b32 v162, 0
    v_mov_b32 v163, 0
    v_mov_b32 v164, 0
    v_mov_b32 v165, 0
    v_mov_b32 v166, 0
    v_mov_b32 v167, 0
    v_mov_b32 v168, 0
    v_mov_b32 v169, 0
    v_mov_b32 v170, 0
    v_mov_b32 v171, 0
    v_mov_b32 v172, 0
    v_mov_b32 v173, 0
    v_mov_b32 v174, 0
    v_mov_b32 v175, 0
    v_mov_b32 v176, 0
    v_mov_b32 v177, 0
    v_mov_b32 v178, 0
    v_mov_b32 v179, 0
    v_mov_b32 v180, 0
    v_mov_b32 v181, 0
    v_mov_b32 v182, 0
    v_mov_b32 v183, 0
    v_mov_b32 v184, 0
    v_mov_b32 v185, 0
    v_mov_b32 v186, 0
    v_mov_b32 v187, 0
    v_mov_b32 v188, 0
    v_mov_b32 v189, 0
    v_mov_b32 v190, 0
    v_mov_b32 v191, 0
    v_mov_b32 v192, 0
    v_mov_b32 v193, 0
    v_mov_b32 v194, 0
    v_mov_b32 v195, 0
    v_mov_b32 v196, 0
    v_mov_b32 v197, 0
    v_mov_b32 v198, 0
    v_mov_b32 v199, 0
    v_mov_b32 v200, 0
    v_mov_b32 v201, 0
    v_mov_b32 v202, 0
    v_mov_b32 v203, 0
    v_mov_b32 v204, 0
    v_mov_b32 v205, 0
    v_mov_b32 v206, 0
    v_mov_b32 v207, 0
    v_mov_b32 v208, 0
    v_mov_b32 v209, 0
    v_mov_b32 v210, 0
    v_mov_b32 v211, 0
    v_mov_b32 v212, 0
    v_mov_b32 v213, 0
    v_mov_b32 v214, 0
    v_mov_b32 v215, 0
    v_mov_b32 v216, 0
    v_mov_b32 v217, 0
    v_mov_b32 v218, 0
    v_mov_b32 v219, 0
    v_mov_b32 v220, 0
    v_mov_b32 v221, 0
    v_mov_b32 v222, 0
    v_mov_b32 v223, 0
    v_mov_b32 v224, 0
    v_mov_b32 v225, 0
    v_mov_b32 v226, 0
    v_mov_b32 v227, 0
    v_mov_b32 v228, 0
    v_mov_b32 v229, 0
    v_mov_b32 v230, 0
    v_mov_b32 v231, 0
    v_mov_b32 v232, 0
    v_mov_b32 v233, 0
    v_mov_b32 v234, 0
    v_mov_b32 v235, 0
    v_mov_b32 v236, 0
    v_mov_b32 v237, 0
    v_mov_b32 v238, 0
    v_mov_b32 v239, 0
    v_mov_b32 v240, 0
    v_mov_b32 v241, 0
    v_mov_b32 v242, 0
    v_mov_b32 v243, 0
    v_mov_b32 v244, 0
    v_mov_b32 v245, 0
    v_mov_b32 v246, 0
    v_mov_b32 v247, 0
    v_mov_b32 v248, 0
    v_mov_b32 v249, 0
    v_mov_b32 v250, 0
    v_mov_b32 v251, 0
    v_mov_b32 v252, 0
    v_mov_b32 v253, 0
    v_mov_b32 v254, 0
    v_mov_b32 v255, 0
    s_waitcnt vmcnt(12)
    s_barrier
    ds_read_b128 v[16:19], v4 offset:0
    ds_read_b128 v[24:27], v3 offset:2048
    ds_read_b128 v[20:23], v4 offset:1024
    ds_read_b128 v[28:31], v3 offset:5120
    ds_read_b128 v[32:35], v3 offset:8192
    ds_read_b128 v[36:39], v3 offset:11264
    s_waitcnt vmcnt(9) lgkmcnt(0)
    s_barrier
    v_mfma_f32_32x32x16_bf16 v[128:143], v[16:19], v[24:27], v[128:143]
    ds_read_b128 v[40:43], v4 offset:12288
    ds_read_b128 v[48:51], v3 offset:14336
    v_mfma_f32_32x32x16_bf16 v[192:207], v[20:23], v[24:27], v[192:207]
    ds_read_b128 v[44:47], v4 offset:13312
    ds_read_b128 v[52:55], v3 offset:17408
    v_mfma_f32_32x32x16_bf16 v[144:159], v[16:19], v[28:31], v[144:159]
    ds_read_b128 v[56:59], v3 offset:20480
    ds_read_b128 v[60:63], v3 offset:23552
    v_mfma_f32_32x32x16_bf16 v[208:223], v[20:23], v[28:31], v[208:223]
    s_add_u32 s26, s25, 61440
    s_mov_b32 m0, s26
    s_add_u32 s26, s26, 1024
    buffer_load_dwordx4 v3, s[80:83], s22 offen lds
    s_add_u32 s22, s22, 1024
    v_mfma_f32_32x32x16_bf16 v[160:175], v[16:19], v[32:35], v[160:175]
    s_mov_b32 m0, s26
    s_add_u32 s26, s26, 1024
    buffer_load_dwordx4 v3, s[80:83], s23 offen lds
    s_add_u32 s23, s23, 1024
    v_mfma_f32_32x32x16_bf16 v[224:239], v[20:23], v[32:35], v[224:239]
    s_mov_b32 m0, s26
    s_nop 0
    buffer_load_dwordx4 v3, s[80:83], s24 offen lds
    s_add_u32 s24, s24, 1024
    v_mfma_f32_32x32x16_bf16 v[176:191], v[16:19], v[36:39], v[176:191]
    v_mfma_f32_32x32x16_bf16 v[240:255], v[20:23], v[36:39], v[240:255]
    s_waitcnt vmcnt(9) lgkmcnt(0)
    s_barrier
    v_mfma_f32_32x32x16_bf16 v[128:143], v[40:43], v[48:51], v[128:143]
    ds_read_b128 v[16:19], v4 offset:24576
    ds_read_b128 v[24:27], v3 offset:26624
    v_mfma_f32_32x32x16_bf16 v[192:207], v[44:47], v[48:51], v[192:207]
    ds_read_b128 v[20:23], v4 offset:25600
    ds_read_b128 v[28:31], v3 offset:29696
    v_mfma_f32_32x32x16_bf16 v[144:159], v[40:43], v[52:55], v[144:159]
    ds_read_b128 v[32:35], v3 offset:32768
    ds_read_b128 v[36:39], v3 offset:35840
    v_mfma_f32_32x32x16_bf16 v[208:223], v[44:47], v[52:55], v[208:223]
    s_add_u32 s26, s25, 0
    s_mov_b32 m0, s26
    s_add_u32 s26, s26, 1024
    buffer_load_dwordx4 v3, s[80:83], s22 offen lds
    s_add_u32 s22, s22, 1024
    v_mfma_f32_32x32x16_bf16 v[160:175], v[40:43], v[56:59], v[160:175]
    s_mov_b32 m0, s26
    s_add_u32 s26, s26, 1024
    buffer_load_dwordx4 v3, s[80:83], s23 offen lds
    s_add_u32 s23, s23, 1024
    v_mfma_f32_32x32x16_bf16 v[224:239], v[44:47], v[56:59], v[224:239]
    s_mov_b32 m0, s26
    s_nop 0
    buffer_load_dwordx4 v3, s[80:83], s24 offen lds
    s_add_u32 s24, s24, 1024
    v_mfma_f32_32x32x16_bf16 v[176:191], v[40:43], v[60:63], v[176:191]
    v_mfma_f32_32x32x16_bf16 v[240:255], v[44:47], v[60:63], v[240:255]
    s_waitcnt vmcnt(9) lgkmcnt(0)
    s_barrier
    v_mfma_f32_32x32x16_bf16 v[128:143], v[16:19], v[24:27], v[128:143]
    ds_read_b128 v[40:43], v5 offset:0
    ds_read_b128 v[48:51], v6 offset:2048
    v_mfma_f32_32x32x16_bf16 v[192:207], v[20:23], v[24:27], v[192:207]
    ds_read_b128 v[44:47], v5 offset:1024
    ds_read_b128 v[52:55], v6 offset:5120
    v_mfma_f32_32x32x16_bf16 v[144:159], v[16:19], v[28:31], v[144:159]
    ds_read_b128 v[56:59], v6 offset:8192
    ds_read_b128 v[60:63], v6 offset:11264
    v_mfma_f32_32x32x16_bf16 v[208:223], v[20:23], v[28:31], v[208:223]
    s_add_u32 s26, s25, 12288
    s_mov_b32 m0, s26
    s_add_u32 s26, s26, 1024
    buffer_load_dwordx4 v3, s[80:83], s22 offen lds
    s_add_u32 s22, s22, 1024
    v_mfma_f32_32x32x16_bf16 v[160:175], v[16:19], v[32:35], v[160:175]
    s_mov_b32 m0, s26
    s_add_u32 s26, s26, 1024
    buffer_load_dwordx4 v3, s[80:83], s23 offen lds
    s_add_u32 s23, s23, 1024
    v_mfma_f32_32x32x16_bf16 v[224:239], v[20:23], v[32:35], v[224:239]
    s_mov_b32 m0, s26
    s_nop 0
    buffer_load_dwordx4 v3, s[80:83], s24 offen lds
    s_add_u32 s24, s24, 1024
    v_mfma_f32_32x32x16_bf16 v[176:191], v[16:19], v[36:39], v[176:191]
    v_mfma_f32_32x32x16_bf16 v[240:255], v[20:23], v[36:39], v[240:255]
    s_waitcnt vmcnt(9) lgkmcnt(0)
    s_barrier
    v_mfma_f32_32x32x16_bf16 v[128:143], v[40:43], v[48:51], v[128:143]
    ds_read_b128 v[16:19], v5 offset:12288
    ds_read_b128 v[24:27], v6 offset:14336
    v_mfma_f32_32x32x16_bf16 v[192:207], v[44:47], v[48:51], v[192:207]
    ds_read_b128 v[20:23], v5 offset:13312
    ds_read_b128 v[28:31], v6 offset:17408
    v_mfma_f32_32x32x16_bf16 v[144:159], v[40:43], v[52:55], v[144:159]
    ds_read_b128 v[32:35], v6 offset:20480
    ds_read_b128 v[36:39], v6 offset:23552
    v_mfma_f32_32x32x16_bf16 v[208:223], v[44:47], v[52:55], v[208:223]
    s_add_u32 s26, s25, 24576
    s_mov_b32 m0, s26
    s_add_u32 s26, s26, 1024
    buffer_load_dwordx4 v3, s[80:83], s22 offen lds
    s_add_u32 s22, s22, 1024
    v_mfma_f32_32x32x16_bf16 v[160:175], v[40:43], v[56:59], v[160:175]
    s_mov_b32 m0, s26
    s_add_u32 s26, s26, 1024
    buffer_load_dwordx4 v3, s[80:83], s23 offen lds
    s_add_u32 s23, s23, 1024
    v_mfma_f32_32x32x16_bf16 v[224:239], v[44:47], v[56:59], v[224:239]
    s_mov_b32 m0, s26
    s_nop 0
    buffer_load_dwordx4 v3, s[80:83], s24 offen lds
    s_add_u32 s24, s24, 1024
    v_mfma_f32_32x32x16_bf16 v[176:191], v[40:43], v[60:63], v[176:191]
    v_mfma_f32_32x32x16_bf16 v[240:255], v[44:47], v[60:63], v[240:255]
    s_waitcnt vmcnt(9) lgkmcnt(0)
    s_barrier
    v_mfma_f32_32x32x16_bf16 v[128:143], v[16:19], v[24:27], v[128:143]
    ds_read_b128 v[40:43], v5 offset:24576
    ds_read_b128 v[48:51], v6 offset:26624
    v_mfma_f32_32x32x16_bf16 v[192:207], v[20:23], v[24:27], v[192:207]
    ds_read_b128 v[44:47], v5 offset:25600
    ds_read_b128 v[52:55], v6 offset:29696
    v_mfma_f32_32x32x16_bf16 v[144:159], v[16:19], v[28:31], v[144:159]
    ds_read_b128 v[56:59], v6 offset:32768
    ds_read_b128 v[60:63], v6 offset:35840
    v_mfma_f32_32x32x16_bf16 v[208:223], v[20:23], v[28:31], v[208:223]
    s_add_u32 s26, s25, 36864
    s_mov_b32 m0, s26
    s_add_u32 s26, s26, 1024
    buffer_load_dwordx4 v3, s[80:83], s22 offen lds
    s_add_u32 s22, s22, 1024
    v_mfma_f32_32x32x16_bf16 v[160:175], v[16:19], v[32:35], v[160:175]
    s_mov_b32 m0, s26
    s_add_u32 s26, s26, 1024
    buffer_load_dwordx4 v3, s[80:83], s23 offen lds
    s_add_u32 s23, s23, 1024
    v_mfma_f32_32x32x16_bf16 v[224:239], v[20:23], v[32:35], v[224:239]
    s_mov_b32 m0, s26
    s_nop 0
    buffer_load_dwordx4 v3, s[80:83], s24 offen lds
    s_add_u32 s24, s24, 1024
    v_mfma_f32_32x32x16_bf16 v[176:191], v[16:19], v[36:39], v[176:191]
    v_mfma_f32_32x32x16_bf16 v[240:255], v[20:23], v[36:39], v[240:255]
    s_waitcnt vmcnt(9) lgkmcnt(0)
    s_barrier
    v_mfma_f32_32x32x16_bf16 v[128:143], v[40:43], v[48:51], v[128:143]
    ds_read_b128 v[16:19], v4 offset:0
    ds_read_b128 v[24:27], v3 offset:2048
    v_mfma_f32_32x32x16_bf16 v[192:207], v[44:47], v[48:51], v[192:207]
    ds_read_b128 v[20:23], v4 offset:1024
    ds_read_b128 v[28:31], v3 offset:5120
    v_mfma_f32_32x32x16_bf16 v[144:159], v[40:43], v[52:55], v[144:159]
    ds_read_b128 v[32:35], v3 offset:8192
    ds_read_b128 v[36:39], v3 offset:11264
    v_mfma_f32_32x32x16_bf16 v[208:223], v[44:47], v[52:55], v[208:223]
    s_add_u32 s26, s25, 49152
    s_mov_b32 m0, s26
    s_add_u32 s26, s26, 1024
    buffer_load_dwordx4 v3, s[80:83], s22 offen lds
    s_add_u32 s22, s22, 1024
    v_mfma_f32_32x32x16_bf16 v[160:175], v[40:43], v[56:59], v[160:175]
    s_mov_b32 m0, s26
    s_add_u32 s26, s26, 1024
    buffer_load_dwordx4 v3, s[80:83], s23 offen lds
    s_add_u32 s23, s23, 1024
    v_mfma_f32_32x32x16_bf16 v[224:239], v[44:47], v[56:59], v[224:239]
    s_mov_b32 m0, s26
    s_nop 0
    buffer_load_dwordx4 v3, s[80:83], s24 offen lds
    s_add_u32 s24, s24, 1024
    v_mfma_f32_32x32x16_bf16 v[176:191], v[40:43], v[60:63], v[176:191]
    v_mfma_f32_32x32x16_bf16 v[240:255], v[44:47], v[60:63], v[240:255]
    s_waitcnt vmcnt(9) lgkmcnt(0)
    s_barrier
    v_mfma_f32_32x32x16_bf16 v[128:143], v[16:19], v[24:27], v[128:143]
    ds_read_b128 v[40:43], v4 offset:12288
    ds_read_b128 v[48:51], v3 offset:14336
    v_mfma_f32_32x32x16_bf16 v[192:207], v[20:23], v[24:27], v[192:207]
    ds_read_b128 v[44:47], v4 offset:13312
    ds_read_b128 v[52:55], v3 offset:17408
    v_mfma_f32_32x32x16_bf16 v[144:159], v[16:19], v[28:31], v[144:159]
    ds_read_b128 v[56:59], v3 offset:20480
    ds_read_b128 v[60:63], v3 offset:23552
    v_mfma_f32_32x32x16_bf16 v[208:223], v[20:23], v[28:31], v[208:223]
    s_add_u32 s26, s25, 61440
    s_mov_b32 m0, s26
    s_add_u32 s26, s26, 1024
    buffer_load_dwordx4 v3, s[80:83], s22 offen lds
    s_add_u32 s22, s22, 1024
    v_mfma_f32_32x32x16_bf16 v[160:175], v[16:19], v[32:35], v[160:175]
    s_mov_b32 m0, s26
    s_add_u32 s26, s26, 1024
    buffer_load_dwordx4 v3, s[80:83], s23 offen lds
    s_add_u32 s23, s23, 1024
    v_mfma_f32_32x32x16_bf16 v[224:239], v[20:23], v[32:35], v[224:239]
    s_mov_b32 m0, s26
    s_nop 0
    buffer_load_dwordx4 v3, s[80:83], s24 offen lds
    s_add_u32 s24, s24, 1024
    v_mfma_f32_32x32x16_bf16 v[176:191], v[16:19], v[36:39], v[176:191]
    v_mfma_f32_32x32x16_bf16 v[240:255], v[20:23], v[36:39], v[240:255]
    s_waitcnt vmcnt(9) lgkmcnt(0)
    s_barrier
    v_mfma_f32_32x32x16_bf16 v[128:143], v[40:43], v[48:51], v[128:143]
    ds_read_b128 v[16:19], v4 offset:24576
    ds_read_b128 v[24:27], v3 offset:26624
    v_mfma_f32_32x32x16_bf16 v[192:207], v[44:47], v[48:51], v[192:207]
    ds_read_b128 v[20:23], v4 offset:25600
    ds_read_b128 v[28:31], v3 offset:29696
    v_mfma_f32_32x32x16_bf16 v[144:159], v[40:43], v[52:55], v[144:159]
    ds_read_b128 v[32:35], v3 offset:32768
    ds_read_b128 v[36:39], v3 offset:35840
    v_mfma_f32_32x32x16_bf16 v[208:223], v[44:47], v[52:55], v[208:223]
    s_add_u32 s26, s25, 0
    s_mov_b32 m0, s26
    s_add_u32 s26, s26, 1024
    buffer_load_dwordx4 v3, s[80:83], s22 offen lds
    s_add_u32 s22, s22, 1024
    v_mfma_f32_32x32x16_bf16 v[160:175], v[40:43], v[56:59], v[160:175]
    s_mov_b32 m0, s26
    s_add_u32 s26, s26, 1024
    buffer_load_dwordx4 v3, s[80:83], s23 offen lds
    s_add_u32 s23, s23, 1024
    v_mfma_f32_32x32x16_bf16 v[224:239], v[44:47], v[56:59], v[224:239]
    s_mov_b32 m0, s26
    s_nop 0
    buffer_load_dwordx4 v3, s[80:83], s24 offen lds
    s_add_u32 s24, s24, 1024
    v_mfma_f32_32x32x16_bf16 v[176:191], v[40:43], v[60:63], v[176:191]
    v_mfma_f32_32x32x16_bf16 v[240:255], v[44:47], v[60:63], v[240:255]
    s_waitcnt vmcnt(9) lgkmcnt(0)
    s_barrier
    v_mfma_f32_32x32x16_bf16 v[128:143], v[16:19], v[24:27], v[128:143]
    ds_read_b128 v[40:43], v5 offset:0
    ds_read_b128 v[48:51], v6 offset:2048
    v_mfma_f32_32x32x16_bf16 v[192:207], v[20:23], v[24:27], v[192:207]
    ds_read_b128 v[44:47], v5 offset:1024
    ds_read_b128 v[52:55], v6 offset:5120
    v_mfma_f32_32x32x16_bf16 v[144:159], v[16:19], v[28:31], v[144:159]
    ds_read_b128 v[56:59], v6 offset:8192
    ds_read_b128 v[60:63], v6 offset:11264
    v_mfma_f32_32x32x16_bf16 v[208:223], v[20:23], v[28:31], v[208:223]
    s_add_u32 s26, s25, 12288
    s_mov_b32 m0, s26
    s_add_u32 s26, s26, 1024
    buffer_load_dwordx4 v3, s[80:83], s22 offen lds
    s_add_u32 s22, s22, 1024
    v_mfma_f32_32x32x16_bf16 v[160:175], v[16:19], v[32:35], v[160:175]
    s_mov_b32 m0, s26
    s_add_u32 s26, s26, 1024
    buffer_load_dwordx4 v3, s[80:83], s23 offen lds
    s_add_u32 s23, s23, 1024
    v_mfma_f32_32x32x16_bf16 v[224:239], v[20:23], v[32:35], v[224:239]
    s_mov_b32 m0, s26
    s_nop 0
    buffer_load_dwordx4 v3, s[80:83], s24 offen lds
    s_add_u32 s24, s24, 1024
    v_mfma_f32_32x32x16_bf16 v[176:191], v[16:19], v[36:39], v[176:191]
    v_mfma_f32_32x32x16_bf16 v[240:255], v[20:23], v[36:39], v[240:255]
    s_waitcnt vmcnt(9) lgkmcnt(0)
    s_barrier
    v_mfma_f32_32x32x16_bf16 v[128:143], v[40:43], v[48:51], v[128:143]
    ds_read_b128 v[16:19], v5 offset:12288
    ds_read_b128 v[24:27], v6 offset:14336
    v_mfma_f32_32x32x16_bf16 v[192:207], v[44:47], v[48:51], v[192:207]
    ds_read_b128 v[20:23], v5 offset:13312
    ds_read_b128 v[28:31], v6 offset:17408
    v_mfma_f32_32x32x16_bf16 v[144:159], v[40:43], v[52:55], v[144:159]
    ds_read_b128 v[32:35], v6 offset:20480
    ds_read_b128 v[36:39], v6 offset:23552
    v_mfma_f32_32x32x16_bf16 v[208:223], v[44:47], v[52:55], v[208:223]
    s_add_u32 s26, s25, 24576
    s_mov_b32 m0, s26
    s_add_u32 s26, s26, 1024
    buffer_load_dwordx4 v3, s[80:83], s22 offen lds
    s_add_u32 s22, s22, 1024
    v_mfma_f32_32x32x16_bf16 v[160:175], v[40:43], v[56:59], v[160:175]
    s_mov_b32 m0, s26
    s_add_u32 s26, s26, 1024
    buffer_load_dwordx4 v3, s[80:83], s23 offen lds
    s_add_u32 s23, s23, 1024
    v_mfma_f32_32x32x16_bf16 v[224:239], v[44:47], v[56:59], v[224:239]
    s_mov_b32 m0, s26
    s_nop 0
    buffer_load_dwordx4 v3, s[80:83], s24 offen lds
    s_add_u32 s24, s24, 1024
    v_mfma_f32_32x32x16_bf16 v[176:191], v[40:43], v[60:63], v[176:191]
    v_mfma_f32_32x32x16_bf16 v[240:255], v[44:47], v[60:63], v[240:255]
    s_waitcnt vmcnt(9) lgkmcnt(0)
    s_barrier
    v_mfma_f32_32x32x16_bf16 v[128:143], v[16:19], v[24:27], v[128:143]
    ds_read_b128 v[40:43], v5 offset:24576
    ds_read_b128 v[48:51], v6 offset:26624
    v_mfma_f32_32x32x16_bf16 v[192:207], v[20:23], v[24:27], v[192:207]
    ds_read_b128 v[44:47], v5 offset:25600
    ds_read_b128 v[52:55], v6 offset:29696
    v_mfma_f32_32x32x16_bf16 v[144:159], v[16:19], v[28:31], v[144:159]
    ds_read_b128 v[56:59], v6 offset:32768
    ds_read_b128 v[60:63], v6 offset:35840
    v_mfma_f32_32x32x16_bf16 v[208:223], v[20:23], v[28:31], v[208:223]
    s_add_u32 s26, s25, 36864
    s_mov_b32 m0, s26
    s_add_u32 s26, s26, 1024
    buffer_load_dwordx4 v3, s[80:83], s22 offen lds
    s_add_u32 s22, s22, 1024
    v_mfma_f32_32x32x16_bf16 v[160:175], v[16:19], v[32:35], v[160:175]
    s_mov_b32 m0, s26
    s_add_u32 s26, s26, 1024
    buffer_load_dwordx4 v3, s[80:83], s23 offen lds
    s_add_u32 s23, s23, 1024
    v_mfma_f32_32x32x16_bf16 v[224:239], v[20:23], v[32:35], v[224:239]
    s_mov_b32 m0, s26
    s_nop 0
    buffer_load_dwordx4 v3, s[80:83], s24 offen lds
    s_add_u32 s24, s24, 1024
    v_mfma_f32_32x32x16_bf16 v[176:191], v[16:19], v[36:39], v[176:191]
    v_mfma_f32_32x32x16_bf16 v[240:255], v[20:23], v[36:39], v[240:255]
    s_waitcnt vmcnt(9) lgkmcnt(0)
    s_barrier
    v_mfma_f32_32x32x16_bf16 v[128:143], v[40:43], v[48:51], v[128:143]
    ds_read_b128 v[16:19], v4 offset:0
    ds_read_b128 v[24:27], v3 offset:2048
    v_mfma_f32_32x32x16_bf16 v[192:207], v[44:47], v[48:51], v[192:207]
    ds_read_b128 v[20:23], v4 offset:1024
    ds_read_b128 v[28:31], v3 offset:5120
    v_mfma_f32_32x32x16_bf16 v[144:159], v[40:43], v[52:55], v[144:159]
    ds_read_b128 v[32:35], v3 offset:8192
    ds_read_b128 v[36:39], v3 offset:11264
    v_mfma_f32_32x32x16_bf16 v[208:223], v[44:47], v[52:55], v[208:223]
    s_add_u32 s26, s25, 49152
    s_mov_b32 m0, s26
    s_add_u32 s26, s26, 1024
    buffer_load_dwordx4 v3, s[80:83], s22 offen lds
    s_add_u32 s22, s22, 1024
    v_mfma_f32_32x32x16_bf16 v[160:175], v[40:43], v[56:59], v[160:175]
    s_mov_b32 m0, s26
    s_add_u32 s26, s26, 1024
    buffer_load_dwordx4 v3, s[80:83], s23 offen lds
    s_add_u32 s23, s23, 1024
    v_mfma_f32_32x32x16_bf16 v[224:239], v[44:47], v[56:59], v[224:239]
    s_mov_b32 m0, s26
    s_nop 0
    buffer_load_dwordx4 v3, s[80:83], s24 offen lds
    s_add_u32 s24, s24, 1024
    v_mfma_f32_32x32x16_bf16 v[176:191], v[40:43], v[60:63], v[176:191]
    v_mfma_f32_32x32x16_bf16 v[240:255], v[44:47], v[60:63], v[240:255]
    s_waitcnt vmcnt(9) lgkmcnt(0)
    s_barrier
    v_mfma_f32_32x32x16_bf16 v[128:143], v[16:19], v[24:27], v[128:143]
    ds_read_b128 v[40:43], v4 offset:12288
    ds_read_b128 v[48:51], v3 offset:14336
    v_mfma_f32_32x32x16_bf16 v[192:207], v[20:23], v[24:27], v[192:207]
    ds_read_b128 v[44:47], v4 offset:13312
    ds_read_b128 v[52:55], v3 offset:17408
    v_mfma_f32_32x32x16_bf16 v[144:159], v[16:19], v[28:31], v[144:159]
    ds_read_b128 v[56:59], v3 offset:20480
    ds_read_b128 v[60:63], v3 offset:23552
    v_mfma_f32_32x32x16_bf16 v[208:223], v[20:23], v[28:31], v[208:223]
    s_add_u32 s26, s25, 61440
    s_mov_b32 m0, s26
    s_add_u32 s26, s26, 1024
    buffer_load_dwordx4 v3, s[80:83], s22 offen lds
    s_add_u32 s22, s22, 1024
    v_mfma_f32_32x32x16_bf16 v[160:175], v[16:19], v[32:35], v[160:175]
    s_mov_b32 m0, s26
    s_add_u32 s26, s26, 1024
    buffer_load_dwordx4 v3, s[80:83], s23 offen lds
    s_add_u32 s23, s23, 1024
    v_mfma_f32_32x32x16_bf16 v[224:239], v[20:23], v[32:35], v[224:239]
    s_mov_b32 m0, s26
    s_nop 0
    buffer_load_dwordx4 v3, s[80:83], s24 offen lds
    s_add_u32 s24, s24, 1024
    v_mfma_f32_32x32x16_bf16 v[176:191], v[16:19], v[36:39], v[176:191]
    v_mfma_f32_32x32x16_bf16 v[240:255], v[20:23], v[36:39], v[240:255]
    s_waitcnt vmcnt(9) lgkmcnt(0)
    s_barrier
    v_mfma_f32_32x32x16_bf16 v[128:143], v[40:43], v[48:51], v[128:143]
    ds_read_b128 v[16:19], v4 offset:24576
    ds_read_b128 v[24:27], v3 offset:26624
    v_mfma_f32_32x32x16_bf16 v[192:207], v[44:47], v[48:51], v[192:207]
    ds_read_b128 v[20:23], v4 offset:25600
    ds_read_b128 v[28:31], v3 offset:29696
    v_mfma_f32_32x32x16_bf16 v[144:159], v[40:43], v[52:55], v[144:159]
    ds_read_b128 v[32:35], v3 offset:32768
    ds_read_b128 v[36:39], v3 offset:35840
    v_mfma_f32_32x32x16_bf16 v[208:223], v[44:47], v[52:55], v[208:223]
    s_add_u32 s26, s25, 0
    s_mov_b32 m0, s26
    s_add_u32 s26, s26, 1024
    buffer_load_dwordx4 v3, s[80:83], s22 offen lds
    s_add_u32 s22, s22, 1024
    v_mfma_f32_32x32x16_bf16 v[160:175], v[40:43], v[56:59], v[160:175]
    s_mov_b32 m0, s26
    s_add_u32 s26, s26, 1024
    buffer_load_dwordx4 v3, s[80:83], s23 offen lds
    s_add_u32 s23, s23, 1024
    v_mfma_f32_32x32x16_bf16 v[224:239], v[44:47], v[56:59], v[224:239]
    s_mov_b32 m0, s26
    s_nop 0
    buffer_load_dwordx4 v3, s[80:83], s24 offen lds
    s_add_u32 s24, s24, 1024
    v_mfma_f32_32x32x16_bf16 v[176:191], v[40:43], v[60:63], v[176:191]
    v_mfma_f32_32x32x16_bf16 v[240:255], v[44:47], v[60:63], v[240:255]
    s_waitcnt vmcnt(9) lgkmcnt(0)
    s_barrier
    v_mfma_f32_32x32x16_bf16 v[128:143], v[16:19], v[24:27], v[128:143]
    ds_read_b128 v[40:43], v5 offset:0
    ds_read_b128 v[48:51], v6 offset:2048
    v_mfma_f32_32x32x16_bf16 v[192:207], v[20:23], v[24:27], v[192:207]
    ds_read_b128 v[44:47], v5 offset:1024
    ds_read_b128 v[52:55], v6 offset:5120
    v_mfma_f32_32x32x16_bf16 v[144:159], v[16:19], v[28:31], v[144:159]
    ds_read_b128 v[56:59], v6 offset:8192
    ds_read_b128 v[60:63], v6 offset:11264
    v_mfma_f32_32x32x16_bf16 v[208:223], v[20:23], v[28:31], v[208:223]
    s_add_u32 s26, s25, 12288
    s_mov_b32 m0, s26
    s_add_u32 s26, s26, 1024
    buffer_load_dwordx4 v3, s[80:83], s22 offen lds
    s_add_u32 s22, s22, 1024
    v_mfma_f32_32x32x16_bf16 v[160:175], v[16:19], v[32:35], v[160:175]
    s_mov_b32 m0, s26
    s_add_u32 s26, s26, 1024
    buffer_load_dwordx4 v3, s[80:83], s23 offen lds
    s_add_u32 s23, s23, 1024
    v_mfma_f32_32x32x16_bf16 v[224:239], v[20:23], v[32:35], v[224:239]
    s_mov_b32 m0, s26
    s_nop 0
    buffer_load_dwordx4 v3, s[80:83], s24 offen lds
    s_add_u32 s24, s24, 1024
    v_mfma_f32_32x32x16_bf16 v[176:191], v[16:19], v[36:39], v[176:191]
    v_mfma_f32_32x32x16_bf16 v[240:255], v[20:23], v[36:39], v[240:255]
    s_waitcnt vmcnt(9) lgkmcnt(0)
    s_barrier
    v_mfma_f32_32x32x16_bf16 v[128:143], v[40:43], v[48:51], v[128:143]
    ds_read_b128 v[16:19], v5 offset:12288
    ds_read_b128 v[24:27], v6 offset:14336
    v_mfma_f32_32x32x16_bf16 v[192:207], v[44:47], v[48:51], v[192:207]
    ds_read_b128 v[20:23], v5 offset:13312
    ds_read_b128 v[28:31], v6 offset:17408
    v_mfma_f32_32x32x16_bf16 v[144:159], v[40:43], v[52:55], v[144:159]
    ds_read_b128 v[32:35], v6 offset:20480
    ds_read_b128 v[36:39], v6 offset:23552
    v_mfma_f32_32x32x16_bf16 v[208:223], v[44:47], v[52:55], v[208:223]
    s_add_u32 s26, s25, 24576
    s_mov_b32 m0, s26
    s_add_u32 s26, s26, 1024
    buffer_load_dwordx4 v3, s[80:83], s22 offen lds
    s_add_u32 s22, s22, 1024
    v_mfma_f32_32x32x16_bf16 v[160:175], v[40:43], v[56:59], v[160:175]
    s_mov_b32 m0, s26
    s_add_u32 s26, s26, 1024
    buffer_load_dwordx4 v3, s[80:83], s23 offen lds
    s_add_u32 s23, s23, 1024
    v_mfma_f32_32x32x16_bf16 v[224:239], v[44:47], v[56:59], v[224:239]
    s_mov_b32 m0, s26
    s_nop 0
    buffer_load_dwordx4 v3, s[80:83], s24 offen lds
    s_add_u32 s24, s24, 1024
    v_mfma_f32_32x32x16_bf16 v[176:191], v[40:43], v[60:63], v[176:191]
    v_mfma_f32_32x32x16_bf16 v[240:255], v[44:47], v[60:63], v[240:255]
    s_waitcnt vmcnt(9) lgkmcnt(0)
    s_barrier
    v_mfma_f32_32x32x16_bf16 v[128:143], v[16:19], v[24:27], v[128:143]
    ds_read_b128 v[40:43], v5 offset:24576
    ds_read_b128 v[48:51], v6 offset:26624
    v_mfma_f32_32x32x16_bf16 v[192:207], v[20:23], v[24:27], v[192:207]
    ds_read_b128 v[44:47], v5 offset:25600
    ds_read_b128 v[52:55], v6 offset:29696
    v_mfma_f32_32x32x16_bf16 v[144:159], v[16:19], v[28:31], v[144:159]
    ds_read_b128 v[56:59], v6 offset:32768
    ds_read_b128 v[60:63], v6 offset:35840
    v_mfma_f32_32x32x16_bf16 v[208:223], v[20:23], v[28:31], v[208:223]
    s_add_u32 s26, s25, 36864
    s_mov_b32 m0, s26
    s_add_u32 s26, s26, 1024
    buffer_load_dwordx4 v3, s[80:83], s22 offen lds
    s_add_u32 s22, s22, 1024
    v_mfma_f32_32x32x16_bf16 v[160:175], v[16:19], v[32:35], v[160:175]
    s_mov_b32 m0, s26
    s_add_u32 s26, s26, 1024
    buffer_load_dwordx4 v3, s[80:83], s23 offen lds
    s_add_u32 s23, s23, 1024
    v_mfma_f32_32x32x16_bf16 v[224:239], v[20:23], v[32:35], v[224:239]
    s_mov_b32 m0, s26
    s_nop 0
    buffer_load_dwordx4 v3, s[80:83], s24 offen lds
    s_add_u32 s24, s24, 1024
    v_mfma_f32_32x32x16_bf16 v[176:191], v[16:19], v[36:39], v[176:191]
    v_mfma_f32_32x32x16_bf16 v[240:255], v[20:23], v[36:39], v[240:255]
    s_waitcnt vmcnt(9) lgkmcnt(0)
    s_barrier
    v_mfma_f32_32x32x16_bf16 v[128:143], v[40:43], v[48:51], v[128:143]
    ds_read_b128 v[16:19], v4 offset:0
    ds_read_b128 v[24:27], v3 offset:2048
    v_mfma_f32_32x32x16_bf16 v[192:207], v[44:47], v[48:51], v[192:207]
    ds_read_b128 v[20:23], v4 offset:1024
    ds_read_b128 v[28:31], v3 offset:5120
    v_mfma_f32_32x32x16_bf16 v[144:159], v[40:43], v[52:55], v[144:159]
    ds_read_b128 v[32:35], v3 offset:8192
    ds_read_b128 v[36:39], v3 offset:11264
    v_mfma_f32_32x32x16_bf16 v[208:223], v[44:47], v[52:55], v[208:223]
    s_add_u32 s26, s25, 49152
    s_mov_b32 m0, s26
    s_add_u32 s26, s26, 1024
    buffer_load_dwordx4 v3, s[80:83], s22 offen lds
    s_add_u32 s22, s22, 1024
    v_mfma_f32_32x32x16_bf16 v[160:175], v[40:43], v[56:59], v[160:175]
    s_mov_b32 m0, s26
    s_add_u32 s26, s26, 1024
    buffer_load_dwordx4 v3, s[80:83], s23 offen lds
    s_add_u32 s23, s23, 1024
    v_mfma_f32_32x32x16_bf16 v[224:239], v[44:47], v[56:59], v[224:239]
    s_mov_b32 m0, s26
    s_nop 0
    buffer_load_dwordx4 v3, s[80:83], s24 offen lds
    s_add_u32 s24, s24, 1024
    v_mfma_f32_32x32x16_bf16 v[176:191], v[40:43], v[60:63], v[176:191]
    v_mfma_f32_32x32x16_bf16 v[240:255], v[44:47], v[60:63], v[240:255]
    s_waitcnt vmcnt(9) lgkmcnt(0)
    s_barrier
    v_mfma_f32_32x32x16_bf16 v[128:143], v[16:19], v[24:27], v[128:143]
    ds_read_b128 v[40:43], v4 offset:12288
    ds_read_b128 v[48:51], v3 offset:14336
    v_mfma_f32_32x32x16_bf16 v[192:207], v[20:23], v[24:27], v[192:207]
    ds_read_b128 v[44:47], v4 offset:13312
    ds_read_b128 v[52:55], v3 offset:17408
    v_mfma_f32_32x32x16_bf16 v[144:159], v[16:19], v[28:31], v[144:159]
    ds_read_b128 v[56:59], v3 offset:20480
    ds_read_b128 v[60:63], v3 offset:23552
    v_mfma_f32_32x32x16_bf16 v[208:223], v[20:23], v[28:31], v[208:223]
    s_add_u32 s26, s25, 61440
    s_mov_b32 m0, s26
    s_add_u32 s26, s26, 1024
    buffer_load_dwordx4 v3, s[80:83], s22 offen lds
    s_add_u32 s22, s22, 1024
    v_mfma_f32_32x32x16_bf16 v[160:175], v[16:19], v[32:35], v[160:175]
    s_mov_b32 m0, s26
    s_add_u32 s26, s26, 1024
    buffer_load_dwordx4 v3, s[80:83], s23 offen lds
    s_add_u32 s23, s23, 1024
    v_mfma_f32_32x32x16_bf16 v[224:239], v[20:23], v[32:35], v[224:239]
    s_mov_b32 m0, s26
    s_nop 0
    buffer_load_dwordx4 v3, s[80:83], s24 offen lds
    s_add_u32 s24, s24, 1024
    v_mfma_f32_32x32x16_bf16 v[176:191], v[16:19], v[36:39], v[176:191]
    v_mfma_f32_32x32x16_bf16 v[240:255], v[20:23], v[36:39], v[240:255]
    s_waitcnt vmcnt(9) lgkmcnt(0)
    s_barrier
    v_mfma_f32_32x32x16_bf16 v[128:143], v[40:43], v[48:51], v[128:143]
    ds_read_b128 v[16:19], v4 offset:24576
    ds_read_b128 v[24:27], v3 offset:26624
    v_mfma_f32_32x32x16_bf16 v[192:207], v[44:47], v[48:51], v[192:207]
    ds_read_b128 v[20:23], v4 offset:25600
    ds_read_b128 v[28:31], v3 offset:29696
    v_mfma_f32_32x32x16_bf16 v[144:159], v[40:43], v[52:55], v[144:159]
    ds_read_b128 v[32:35], v3 offset:32768
    ds_read_b128 v[36:39], v3 offset:35840
    v_mfma_f32_32x32x16_bf16 v[208:223], v[44:47], v[52:55], v[208:223]
    s_add_u32 s26, s25, 0
    s_mov_b32 m0, s26
    s_add_u32 s26, s26, 1024
    buffer_load_dwordx4 v3, s[80:83], s22 offen lds
    s_add_u32 s22, s22, 1024
    v_mfma_f32_32x32x16_bf16 v[160:175], v[40:43], v[56:59], v[160:175]
    s_mov_b32 m0, s26
    s_add_u32 s26, s26, 1024
    buffer_load_dwordx4 v3, s[80:83], s23 offen lds
    s_add_u32 s23, s23, 1024
    v_mfma_f32_32x32x16_bf16 v[224:239], v[44:47], v[56:59], v[224:239]
    s_mov_b32 m0, s26
    s_nop 0
    buffer_load_dwordx4 v3, s[80:83], s24 offen lds
    s_add_u32 s24, s24, 1024
    v_mfma_f32_32x32x16_bf16 v[176:191], v[40:43], v[60:63], v[176:191]
    v_mfma_f32_32x32x16_bf16 v[240:255], v[44:47], v[60:63], v[240:255]
    s_waitcnt vmcnt(9) lgkmcnt(0)
    s_barrier
    v_mfma_f32_32x32x16_bf16 v[128:143], v[16:19], v[24:27], v[128:143]
    ds_read_b128 v[40:43], v5 offset:0
    ds_read_b128 v[48:51], v6 offset:2048
    v_mfma_f32_32x32x16_bf16 v[192:207], v[20:23], v[24:27], v[192:207]
    ds_read_b128 v[44:47], v5 offset:1024
    ds_read_b128 v[52:55], v6 offset:5120
    v_mfma_f32_32x32x16_bf16 v[144:159], v[16:19], v[28:31], v[144:159]
    ds_read_b128 v[56:59], v6 offset:8192
    ds_read_b128 v[60:63], v6 offset:11264
    v_mfma_f32_32x32x16_bf16 v[208:223], v[20:23], v[28:31], v[208:223]
    s_add_u32 s26, s25, 12288
    s_mov_b32 m0, s26
    s_add_u32 s26, s26, 1024
    buffer_load_dwordx4 v3, s[80:83], s22 offen lds
    s_add_u32 s22, s22, 1024
    v_mfma_f32_32x32x16_bf16 v[160:175], v[16:19], v[32:35], v[160:175]
    s_mov_b32 m0, s26
    s_add_u32 s26, s26, 1024
    buffer_load_dwordx4 v3, s[80:83], s23 offen lds
    s_add_u32 s23, s23, 1024
    v_mfma_f32_32x32x16_bf16 v[224:239], v[20:23], v[32:35], v[224:239]
    s_mov_b32 m0, s26
    s_nop 0
    buffer_load_dwordx4 v3, s[80:83], s24 offen lds
    s_add_u32 s24, s24, 1024
    v_mfma_f32_32x32x16_bf16 v[176:191], v[16:19], v[36:39], v[176:191]
    v_mfma_f32_32x32x16_bf16 v[240:255], v[20:23], v[36:39], v[240:255]
    s_waitcnt vmcnt(9) lgkmcnt(0)
    s_barrier
    v_mfma_f32_32x32x16_bf16 v[128:143], v[40:43], v[48:51], v[128:143]
    ds_read_b128 v[16:19], v5 offset:12288
    ds_read_b128 v[24:27], v6 offset:14336
    v_mfma_f32_32x32x16_bf16 v[192:207], v[44:47], v[48:51], v[192:207]
    ds_read_b128 v[20:23], v5 offset:13312
    ds_read_b128 v[28:31], v6 offset:17408
    v_mfma_f32_32x32x16_bf16 v[144:159], v[40:43], v[52:55], v[144:159]
    ds_read_b128 v[32:35], v6 offset:20480
    ds_read_b128 v[36:39], v6 offset:23552
    v_mfma_f32_32x32x16_bf16 v[208:223], v[44:47], v[52:55], v[208:223]
    s_add_u32 s26, s25, 24576
    s_mov_b32 m0, s26
    s_add_u32 s26, s26, 1024
    buffer_load_dwordx4 v3, s[80:83], s22 offen lds
    s_add_u32 s22, s22, 1024
    v_mfma_f32_32x32x16_bf16 v[160:175], v[40:43], v[56:59], v[160:175]
    s_mov_b32 m0, s26
    s_add_u32 s26, s26, 1024
    buffer_load_dwordx4 v3, s[80:83], s23 offen lds
    s_add_u32 s23, s23, 1024
    v_mfma_f32_32x32x16_bf16 v[224:239], v[44:47], v[56:59], v[224:239]
    s_mov_b32 m0, s26
    s_nop 0
    buffer_load_dwordx4 v3, s[80:83], s24 offen lds
    s_add_u32 s24, s24, 1024
    v_mfma_f32_32x32x16_bf16 v[176:191], v[40:43], v[60:63], v[176:191]
    v_mfma_f32_32x32x16_bf16 v[240:255], v[44:47], v[60:63], v[240:255]
    s_waitcnt vmcnt(9) lgkmcnt(0)
    s_barrier
    v_mfma_f32_32x32x16_bf16 v[128:143], v[16:19], v[24:27], v[128:143]
    ds_read_b128 v[40:43], v5 offset:24576
    ds_read_b128 v[48:51], v6 offset:26624
    v_mfma_f32_32x32x16_bf16 v[192:207], v[20:23], v[24:27], v[192:207]
    ds_read_b128 v[44:47], v5 offset:25600
    ds_read_b128 v[52:55], v6 offset:29696
    v_mfma_f32_32x32x16_bf16 v[144:159], v[16:19], v[28:31], v[144:159]
    ds_read_b128 v[56:59], v6 offset:32768
    ds_read_b128 v[60:63], v6 offset:35840
    v_mfma_f32_32x32x16_bf16 v[208:223], v[20:23], v[28:31], v[208:223]
    s_add_u32 s26, s25, 36864
    s_mov_b32 m0, s26
    s_add_u32 s26, s26, 1024
    buffer_load_dwordx4 v3, s[80:83], s22 offen lds
    s_add_u32 s22, s22, 1024
    v_mfma_f32_32x32x16_bf16 v[160:175], v[16:19], v[32:35], v[160:175]
    s_mov_b32 m0, s26
    s_add_u32 s26, s26, 1024
    buffer_load_dwordx4 v3, s[80:83], s23 offen lds
    s_add_u32 s23, s23, 1024
    v_mfma_f32_32x32x16_bf16 v[224:239], v[20:23], v[32:35], v[224:239]
    s_mov_b32 m0, s26
    s_nop 0
    buffer_load_dwordx4 v3, s[80:83], s24 offen lds
    s_add_u32 s24, s24, 1024
    v_mfma_f32_32x32x16_bf16 v[176:191], v[16:19], v[36:39], v[176:191]
    v_mfma_f32_32x32x16_bf16 v[240:255], v[20:23], v[36:39], v[240:255]
    s_waitcnt vmcnt(9) lgkmcnt(0)
    s_barrier
    v_mfma_f32_32x32x16_bf16 v[128:143], v[40:43], v[48:51], v[128:143]
    ds_read_b128 v[16:19], v4 offset:0
    ds_read_b128 v[24:27], v3 offset:2048
    v_mfma_f32_32x32x16_bf16 v[192:207], v[44:47], v[48:51], v[192:207]
    ds_read_b128 v[20:23], v4 offset:1024
    ds_read_b128 v[28:31], v3 offset:5120
    v_mfma_f32_32x32x16_bf16 v[144:159], v[40:43], v[52:55], v[144:159]
    ds_read_b128 v[32:35], v3 offset:8192
    ds_read_b128 v[36:39], v3 offset:11264
    v_mfma_f32_32x32x16_bf16 v[208:223], v[44:47], v[52:55], v[208:223]
    s_add_u32 s26, s25, 49152
    s_mov_b32 m0, s26
    s_add_u32 s26, s26, 1024
    buffer_load_dwordx4 v3, s[80:83], s22 offen lds
    s_add_u32 s22, s22, 1024
    v_mfma_f32_32x32x16_bf16 v[160:175], v[40:43], v[56:59], v[160:175]
    s_mov_b32 m0, s26
    s_add_u32 s26, s26, 1024
    buffer_load_dwordx4 v3, s[80:83], s23 offen lds
    s_add_u32 s23, s23, 1024
    v_mfma_f32_32x32x16_bf16 v[224:239], v[44:47], v[56:59], v[224:239]
    s_mov_b32 m0, s26
    s_nop 0
    buffer_load_dwordx4 v3, s[80:83], s24 offen lds
    s_add_u32 s24, s24, 1024
    v_mfma_f32_32x32x16_bf16 v[176:191], v[40:43], v[60:63], v[176:191]
    v_mfma_f32_32x32x16_bf16 v[240:255], v[44:47], v[60:63], v[240:255]
    s_waitcnt vmcnt(9) lgkmcnt(0)
    s_barrier
    v_mfma_f32_32x32x16_bf16 v[128:143], v[16:19], v[24:27], v[128:143]
    ds_read_b128 v[40:43], v4 offset:12288
    ds_read_b128 v[48:51], v3 offset:14336
    v_mfma_f32_32x32x16_bf16 v[192:207], v[20:23], v[24:27], v[192:207]
    ds_read_b128 v[44:47], v4 offset:13312
    ds_read_b128 v[52:55], v3 offset:17408
    v_mfma_f32_32x32x16_bf16 v[144:159], v[16:19], v[28:31], v[144:159]
    ds_read_b128 v[56:59], v3 offset:20480
    ds_read_b128 v[60:63], v3 offset:23552
    v_mfma_f32_32x32x16_bf16 v[208:223], v[20:23], v[28:31], v[208:223]
    s_add_u32 s26, s25, 61440
    s_mov_b32 m0, s26
    s_add_u32 s26, s26, 1024
    buffer_load_dwordx4 v3, s[80:83], s22 offen lds
    s_add_u32 s22, s22, 1024
    v_mfma_f32_32x32x16_bf16 v[160:175], v[16:19], v[32:35], v[160:175]
    s_mov_b32 m0, s26
    s_add_u32 s26, s26, 1024
    buffer_load_dwordx4 v3, s[80:83], s23 offen lds
    s_add_u32 s23, s23, 1024
    v_mfma_f32_32x32x16_bf16 v[224:239], v[20:23], v[32:35], v[224:239]
    s_mov_b32 m0, s26
    s_nop 0
    buffer_load_dwordx4 v3, s[80:83], s24 offen lds
    s_add_u32 s24, s24, 1024
    v_mfma_f32_32x32x16_bf16 v[176:191], v[16:19], v[36:39], v[176:191]
    v_mfma_f32_32x32x16_bf16 v[240:255], v[20:23], v[36:39], v[240:255]
    s_waitcnt vmcnt(9) lgkmcnt(0)
    s_barrier
    v_mfma_f32_32x32x16_bf16 v[128:143], v[40:43], v[48:51], v[128:143]
    ds_read_b128 v[16:19], v4 offset:24576
    ds_read_b128 v[24:27], v3 offset:26624
    v_mfma_f32_32x32x16_bf16 v[192:207], v[44:47], v[48:51], v[192:207]
    ds_read_b128 v[20:23], v4 offset:25600
    ds_read_b128 v[28:31], v3 offset:29696
    v_mfma_f32_32x32x16_bf16 v[144:159], v[40:43], v[52:55], v[144:159]
    ds_read_b128 v[32:35], v3 offset:32768
    ds_read_b128 v[36:39], v3 offset:35840
    v_mfma_f32_32x32x16_bf16 v[208:223], v[44:47], v[52:55], v[208:223]
    s_add_u32 s26, s25, 0
    s_mov_b32 m0, s26
    s_add_u32 s26, s26, 1024
    buffer_load_dwordx4 v3, s[80:83], s22 offen lds
    s_add_u32 s22, s22, 1024
    v_mfma_f32_32x32x16_bf16 v[160:175], v[40:43], v[56:59], v[160:175]
    s_mov_b32 m0, s26
    s_add_u32 s26, s26, 1024
    buffer_load_dwordx4 v3, s[80:83], s23 offen lds
    s_add_u32 s23, s23, 1024
    v_mfma_f32_32x32x16_bf16 v[224:239], v[44:47], v[56:59], v[224:239]
    s_mov_b32 m0, s26
    s_nop 0
    buffer_load_dwordx4 v3, s[80:83], s24 offen lds
    s_add_u32 s24, s24, 1024
    v_mfma_f32_32x32x16_bf16 v[176:191], v[40:43], v[60:63], v[176:191]
    v_mfma_f32_32x32x16_bf16 v[240:255], v[44:47], v[60:63], v[240:255]
    s_waitcnt vmcnt(9) lgkmcnt(0)
    s_barrier
    v_mfma_f32_32x32x16_bf16 v[128:143], v[16:19], v[24:27], v[128:143]
    ds_read_b128 v[40:43], v5 offset:0
    ds_read_b128 v[48:51], v6 offset:2048
    v_mfma_f32_32x32x16_bf16 v[192:207], v[20:23], v[24:27], v[192:207]
    ds_read_b128 v[44:47], v5 offset:1024
    ds_read_b128 v[52:55], v6 offset:5120
    v_mfma_f32_32x32x16_bf16 v[144:159], v[16:19], v[28:31], v[144:159]
    ds_read_b128 v[56:59], v6 offset:8192
    ds_read_b128 v[60:63], v6 offset:11264
    v_mfma_f32_32x32x16_bf16 v[208:223], v[20:23], v[28:31], v[208:223]
    s_add_u32 s26, s25, 12288
    s_mov_b32 m0, s26
    s_add_u32 s26, s26, 1024
    buffer_load_dwordx4 v3, s[80:83], s22 offen lds
    s_add_u32 s22, s22, 1024
    v_mfma_f32_32x32x16_bf16 v[160:175], v[16:19], v[32:35], v[160:175]
    s_mov_b32 m0, s26
    s_add_u32 s26, s26, 1024
    buffer_load_dwordx4 v3, s[80:83], s23 offen lds
    s_add_u32 s23, s23, 1024
    v_mfma_f32_32x32x16_bf16 v[224:239], v[20:23], v[32:35], v[224:239]
    s_mov_b32 m0, s26
    s_nop 0
    buffer_load_dwordx4 v3, s[80:83], s24 offen lds
    s_add_u32 s24, s24, 1024
    v_mfma_f32_32x32x16_bf16 v[176:191], v[16:19], v[36:39], v[176:191]
    v_mfma_f32_32x32x16_bf16 v[240:255], v[20:23], v[36:39], v[240:255]
    s_waitcnt vmcnt(9) lgkmcnt(0)
    s_barrier
    v_mfma_f32_32x32x16_bf16 v[128:143], v[40:43], v[48:51], v[128:143]
    ds_read_b128 v[16:19], v5 offset:12288
    ds_read_b128 v[24:27], v6 offset:14336
    v_mfma_f32_32x32x16_bf16 v[192:207], v[44:47], v[48:51], v[192:207]
    ds_read_b128 v[20:23], v5 offset:13312
    ds_read_b128 v[28:31], v6 offset:17408
    v_mfma_f32_32x32x16_bf16 v[144:159], v[40:43], v[52:55], v[144:159]
    ds_read_b128 v[32:35], v6 offset:20480
    ds_read_b128 v[36:39], v6 offset:23552
    v_mfma_f32_32x32x16_bf16 v[208:223], v[44:47], v[52:55], v[208:223]
    v_mfma_f32_32x32x16_bf16 v[160:175], v[40:43], v[56:59], v[160:175]
    v_mfma_f32_32x32x16_bf16 v[224:239], v[44:47], v[56:59], v[224:239]
    v_mfma_f32_32x32x16_bf16 v[176:191], v[40:43], v[60:63], v[176:191]
    v_mfma_f32_32x32x16_bf16 v[240:255], v[44:47], v[60:63], v[240:255]
    s_waitcnt vmcnt(6) lgkmcnt(0)
    s_barrier
    v_mfma_f32_32x32x16_bf16 v[128:143], v[16:19], v[24:27], v[128:143]
    ds_read_b128 v[40:43], v5 offset:24576
    ds_read_b128 v[48:51], v6 offset:26624
    v_mfma_f32_32x32x16_bf16 v[192:207], v[20:23], v[24:27], v[192:207]
    ds_read_b128 v[44:47], v5 offset:25600
    ds_read_b128 v[52:55], v6 offset:29696
    v_mfma_f32_32x32x16_bf16 v[144:159], v[16:19], v[28:31], v[144:159]
    ds_read_b128 v[56:59], v6 offset:32768
    ds_read_b128 v[60:63], v6 offset:35840
    v_mfma_f32_32x32x16_bf16 v[208:223], v[20:23], v[28:31], v[208:223]
    v_mfma_f32_32x32x16_bf16 v[160:175], v[16:19], v[32:35], v[160:175]
    v_mfma_f32_32x32x16_bf16 v[224:239], v[20:23], v[32:35], v[224:239]
    v_mfma_f32_32x32x16_bf16 v[176:191], v[16:19], v[36:39], v[176:191]
    v_mfma_f32_32x32x16_bf16 v[240:255], v[20:23], v[36:39], v[240:255]
    s_waitcnt vmcnt(3) lgkmcnt(0)
    s_barrier
    v_mfma_f32_32x32x16_bf16 v[128:143], v[40:43], v[48:51], v[128:143]
    ds_read_b128 v[16:19], v4 offset:0
    ds_read_b128 v[24:27], v3 offset:2048
    v_mfma_f32_32x32x16_bf16 v[192:207], v[44:47], v[48:51], v[192:207]
    ds_read_b128 v[20:23], v4 offset:1024
    ds_read_b128 v[28:31], v3 offset:5120
    v_mfma_f32_32x32x16_bf16 v[144:159], v[40:43], v[52:55], v[144:159]
    ds_read_b128 v[32:35], v3 offset:8192
    ds_read_b128 v[36:39], v3 offset:11264
    v_mfma_f32_32x32x16_bf16 v[208:223], v[44:47], v[52:55], v[208:223]
    v_mfma_f32_32x32x16_bf16 v[160:175], v[40:43], v[56:59], v[160:175]
    v_mfma_f32_32x32x16_bf16 v[224:239], v[44:47], v[56:59], v[224:239]
    v_mfma_f32_32x32x16_bf16 v[176:191], v[40:43], v[60:63], v[176:191]
    v_mfma_f32_32x32x16_bf16 v[240:255], v[44:47], v[60:63], v[240:255]
    s_waitcnt vmcnt(0) lgkmcnt(0)
    s_barrier
    v_mfma_f32_32x32x16_bf16 v[128:143], v[16:19], v[24:27], v[128:143]
    ds_read_b128 v[40:43], v4 offset:12288
    ds_read_b128 v[48:51], v3 offset:14336
    v_mfma_f32_32x32x16_bf16 v[192:207], v[20:23], v[24:27], v[192:207]
    ds_read_b128 v[44:47], v4 offset:13312
    ds_read_b128 v[52:55], v3 offset:17408
    v_mfma_f32_32x32x16_bf16 v[144:159], v[16:19], v[28:31], v[144:159]
    ds_read_b128 v[56:59], v3 offset:20480
    ds_read_b128 v[60:63], v3 offset:23552
    v_mfma_f32_32x32x16_bf16 v[208:223], v[20:23], v[28:31], v[208:223]
    v_mfma_f32_32x32x16_bf16 v[160:175], v[16:19], v[32:35], v[160:175]
    v_mfma_f32_32x32x16_bf16 v[224:239], v[20:23], v[32:35], v[224:239]
    v_mfma_f32_32x32x16_bf16 v[176:191], v[16:19], v[36:39], v[176:191]
    v_mfma_f32_32x32x16_bf16 v[240:255], v[20:23], v[36:39], v[240:255]
    s_waitcnt lgkmcnt(0)
    v_mfma_f32_32x32x16_bf16 v[128:143], v[40:43], v[48:51], v[128:143]
    v_mfma_f32_32x32x16_bf16 v[192:207], v[44:47], v[48:51], v[192:207]
    v_mfma_f32_32x32x16_bf16 v[144:159], v[40:43], v[52:55], v[144:159]
    v_mfma_f32_32x32x16_bf16 v[208:223], v[44:47], v[52:55], v[208:223]
    v_mfma_f32_32x32x16_bf16 v[160:175], v[40:43], v[56:59], v[160:175]
    v_mfma_f32_32x32x16_bf16 v[224:239], v[44:47], v[56:59], v[224:239]
    v_mfma_f32_32x32x16_bf16 v[176:191], v[40:43], v[60:63], v[176:191]
    v_mfma_f32_32x32x16_bf16 v[240:255], v[44:47], v[60:63], v[240:255]
    s_setprio 0
    v_mov_b32 v60, 0xc0135761
    v_mov_b32 v62, 0xbdd2d3e8
    v_mov_b32 v64, 1.0
    s_mul_i32 s28, s20, 114688
    s_lshl_b32 s29, s19, 11
    s_add_u32 s28, s28, s29
    s_add_u32 s28, s28, 18874368
    s_nop 7
    v_cvt_pk_bf16_f32 v70, v128, v129
    v_cvt_pk_bf16_f32 v78, v130, v131
    v_cvt_pk_bf16_f32 v86, v132, v133
    v_cvt_pk_bf16_f32 v94, v134, v135
    v_cvt_pk_bf16_f32 v72, v192, v193
    v_cvt_pk_bf16_f32 v80, v194, v195
    v_cvt_pk_bf16_f32 v88, v196, v197
    v_cvt_pk_bf16_f32 v96, v198, v199
    v_lshlrev_b32 v66, 16, v70
    v_lshlrev_b32 v74, 16, v78
    v_lshlrev_b32 v82, 16, v86
    v_lshlrev_b32 v90, 16, v94
    v_and_b32 v67, 0xffff0000, v70
    v_and_b32 v75, 0xffff0000, v78
    v_and_b32 v83, 0xffff0000, v86
    v_and_b32 v91, 0xffff0000, v94
    v_mul_f32 v68, v66, v66
    v_mul_f32 v76, v74, v74
    v_mul_f32 v84, v82, v82
    v_mul_f32 v92, v90, v90
    v_mul_f32 v69, v67, v67
    v_mul_f32 v77, v75, v75
    v_mul_f32 v85, v83, v83
    v_mul_f32 v93, v91, v91
    v_fma_f32 v68, v68, v62, v60
    v_fma_f32 v76, v76, v62, v60
    v_fma_f32 v84, v84, v62, v60
    v_fma_f32 v92, v92, v62, v60
    v_fma_f32 v69, v69, v62, v60
    v_fma_f32 v77, v77, v62, v60
    v_fma_f32 v85, v85, v62, v60
    v_fma_f32 v93, v93, v62, v60
    v_mul_f32 v68, v68, v66
    v_mul_f32 v76, v76, v74
    v_mul_f32 v84, v84, v82
    v_mul_f32 v92, v92, v90
    v_mul_f32 v69, v69, v67
    v_mul_f32 v77, v77, v75
    v_mul_f32 v85, v85, v83
    v_mul_f32 v93, v93, v91
    v_exp_f32 v68, v68
    v_exp_f32 v76, v76
    v_exp_f32 v84, v84
    v_exp_f32 v92, v92
    v_exp_f32 v69, v69
    v_exp_f32 v77, v77
    v_exp_f32 v85, v85
    v_exp_f32 v93, v93
    v_lshlrev_b32 v70, 16, v72
    v_lshlrev_b32 v78, 16, v80
    v_lshlrev_b32 v86, 16, v88
    v_lshlrev_b32 v94, 16, v96
    v_and_b32 v71, 0xffff0000, v72
    v_and_b32 v79, 0xffff0000, v80
    v_and_b32 v87, 0xffff0000, v88
    v_and_b32 v95, 0xffff0000, v96
    v_add_f32 v68, 1.0, v68
    v_add_f32 v76, 1.0, v76
    v_add_f32 v84, 1.0, v84
    v_add_f32 v92, 1.0, v92
    v_add_f32 v69, 1.0, v69
    v_add_f32 v77, 1.0, v77
    v_add_f32 v85, 1.0, v85
    v_add_f32 v93, 1.0, v93
    v_rcp_f32 v68, v68
    v_rcp_f32 v76, v76
    v_rcp_f32 v84, v84
    v_rcp_f32 v92, v92
    v_rcp_f32 v69, v69
    v_rcp_f32 v77, v77
    v_rcp_f32 v85, v85
    v_rcp_f32 v93, v93
    v_mul_f32 v68, v68, v66
    v_mul_f32 v76, v76, v74
    v_mul_f32 v84, v84, v82
    v_mul_f32 v92, v92, v90
    v_mul_f32 v69, v69, v67
    v_mul_f32 v77, v77, v75
    v_mul_f32 v85, v85, v83
    v_mul_f32 v93, v93, v91
    v_cvt_pk_bf16_f32 v68, v68, v69
    v_cvt_pk_bf16_f32 v76, v76, v77
    v_cvt_pk_bf16_f32 v84, v84, v85
    v_cvt_pk_bf16_f32 v92, v92, v93
    v_lshlrev_b32 v66, 16, v68
    v_lshlrev_b32 v74, 16, v76
    v_lshlrev_b32 v82, 16, v84
    v_lshlrev_b32 v90, 16, v92
    v_and_b32 v67, 0xffff0000, v68
    v_and_b32 v75, 0xffff0000, v76
    v_and_b32 v83, 0xffff0000, v84
    v_and_b32 v91, 0xffff0000, v92
    v_mul_f32 v66, v66, v70
    v_mul_f32 v74, v74, v78
    v_mul_f32 v82, v82, v86
    v_mul_f32 v90, v90, v94
    v_mul_f32 v67, v67, v71
    v_mul_f32 v75, v75, v79
    v_mul_f32 v83, v83, v87
    v_mul_f32 v91, v91, v95
    v_cvt_pk_bf16_f32 v16, v66, v67
    v_cvt_pk_bf16_f32 v17, v74, v75
    v_cvt_pk_bf16_f32 v18, v82, v83
    v_cvt_pk_bf16_f32 v19, v90, v91
    buffer_store_dwordx4 v[16:19], v3, s[80:83], s28 offen offset:0
    v_cvt_pk_bf16_f32 v70, v136, v137
    v_cvt_pk_bf16_f32 v78, v138, v139
    v_cvt_pk_bf16_f32 v86, v140, v141
    v_cvt_pk_bf16_f32 v94, v142, v143
    v_cvt_pk_bf16_f32 v72, v200, v201
    v_cvt_pk_bf16_f32 v80, v202, v203
    v_cvt_pk_bf16_f32 v88, v204, v205
    v_cvt_pk_bf16_f32 v96, v206, v207
    v_lshlrev_b32 v66, 16, v70
    v_lshlrev_b32 v74, 16, v78
    v_lshlrev_b32 v82, 16, v86
    v_lshlrev_b32 v90, 16, v94
    v_and_b32 v67, 0xffff0000, v70
    v_and_b32 v75, 0xffff0000, v78
    v_and_b32 v83, 0xffff0000, v86
    v_and_b32 v91, 0xffff0000, v94
    v_mul_f32 v68, v66, v66
    v_mul_f32 v76, v74, v74
    v_mul_f32 v84, v82, v82
    v_mul_f32 v92, v90, v90
    v_mul_f32 v69, v67, v67
    v_mul_f32 v77, v75, v75
    v_mul_f32 v85, v83, v83
    v_mul_f32 v93, v91, v91
    v_fma_f32 v68, v68, v62, v60
    v_fma_f32 v76, v76, v62, v60
    v_fma_f32 v84, v84, v62, v60
    v_fma_f32 v92, v92, v62, v60
    v_fma_f32 v69, v69, v62, v60
    v_fma_f32 v77, v77, v62, v60
    v_fma_f32 v85, v85, v62, v60
    v_fma_f32 v93, v93, v62, v60
    v_mul_f32 v68, v68, v66
    v_mul_f32 v76, v76, v74
    v_mul_f32 v84, v84, v82
    v_mul_f32 v92, v92, v90
    v_mul_f32 v69, v69, v67
    v_mul_f32 v77, v77, v75
    v_mul_f32 v85, v85, v83
    v_mul_f32 v93, v93, v91
    v_exp_f32 v68, v68
    v_exp_f32 v76, v76
    v_exp_f32 v84, v84
    v_exp_f32 v92, v92
    v_exp_f32 v69, v69
    v_exp_f32 v77, v77
    v_exp_f32 v85, v85
    v_exp_f32 v93, v93
    v_lshlrev_b32 v70, 16, v72
    v_lshlrev_b32 v78, 16, v80
    v_lshlrev_b32 v86, 16, v88
    v_lshlrev_b32 v94, 16, v96
    v_and_b32 v71, 0xffff0000, v72
    v_and_b32 v79, 0xffff0000, v80
    v_and_b32 v87, 0xffff0000, v88
    v_and_b32 v95, 0xffff0000, v96
    v_add_f32 v68, 1.0, v68
    v_add_f32 v76, 1.0, v76
    v_add_f32 v84, 1.0, v84
    v_add_f32 v92, 1.0, v92
    v_add_f32 v69, 1.0, v69
    v_add_f32 v77, 1.0, v77
    v_add_f32 v85, 1.0, v85
    v_add_f32 v93, 1.0, v93
    v_rcp_f32 v68, v68
    v_rcp_f32 v76, v76
    v_rcp_f32 v84, v84
    v_rcp_f32 v92, v92
    v_rcp_f32 v69, v69
    v_rcp_f32 v77, v77
    v_rcp_f32 v85, v85
    v_rcp_f32 v93, v93
    v_mul_f32 v68, v68, v66
    v_mul_f32 v76, v76, v74
    v_mul_f32 v84, v84, v82
    v_mul_f32 v92, v92, v90
    v_mul_f32 v69, v69, v67
    v_mul_f32 v77, v77, v75
    v_mul_f32 v85, v85, v83
    v_mul_f32 v93, v93, v91
    v_cvt_pk_bf16_f32 v68, v68, v69
    v_cvt_pk_bf16_f32 v76, v76, v77
    v_cvt_pk_bf16_f32 v84, v84, v85
    v_cvt_pk_bf16_f32 v92, v92, v93
    v_lshlrev_b32 v66, 16, v68
    v_lshlrev_b32 v74, 16, v76
    v_lshlrev_b32 v82, 16, v84
    v_lshlrev_b32 v90, 16, v92
    v_and_b32 v67, 0xffff0000, v68
    v_and_b32 v75, 0xffff0000, v76
    v_and_b32 v83, 0xffff0000, v84
    v_and_b32 v91, 0xffff0000, v92
    v_mul_f32 v66, v66, v70
    v_mul_f32 v74, v74, v78
    v_mul_f32 v82, v82, v86
    v_mul_f32 v90, v90, v94
    v_mul_f32 v67, v67, v71
    v_mul_f32 v75, v75, v79
    v_mul_f32 v83, v83, v87
    v_mul_f32 v91, v91, v95
    v_cvt_pk_bf16_f32 v20, v66, v67
    v_cvt_pk_bf16_f32 v21, v74, v75
    v_cvt_pk_bf16_f32 v22, v82, v83
    v_cvt_pk_bf16_f32 v23, v90, v91
    buffer_store_dwordx4 v[20:23], v3, s[80:83], s28 offen offset:1024
    s_add_u32 s28, s28, 114688
    v_cvt_pk_bf16_f32 v70, v144, v145
    v_cvt_pk_bf16_f32 v78, v146, v147
    v_cvt_pk_bf16_f32 v86, v148, v149
    v_cvt_pk_bf16_f32 v94, v150, v151
    v_cvt_pk_bf16_f32 v72, v208, v209
    v_cvt_pk_bf16_f32 v80, v210, v211
    v_cvt_pk_bf16_f32 v88, v212, v213
    v_cvt_pk_bf16_f32 v96, v214, v215
    v_lshlrev_b32 v66, 16, v70
    v_lshlrev_b32 v74, 16, v78
    v_lshlrev_b32 v82, 16, v86
    v_lshlrev_b32 v90, 16, v94
    v_and_b32 v67, 0xffff0000, v70
    v_and_b32 v75, 0xffff0000, v78
    v_and_b32 v83, 0xffff0000, v86
    v_and_b32 v91, 0xffff0000, v94
    v_mul_f32 v68, v66, v66
    v_mul_f32 v76, v74, v74
    v_mul_f32 v84, v82, v82
    v_mul_f32 v92, v90, v90
    v_mul_f32 v69, v67, v67
    v_mul_f32 v77, v75, v75
    v_mul_f32 v85, v83, v83
    v_mul_f32 v93, v91, v91
    v_fma_f32 v68, v68, v62, v60
    v_fma_f32 v76, v76, v62, v60
    v_fma_f32 v84, v84, v62, v60
    v_fma_f32 v92, v92, v62, v60
    v_fma_f32 v69, v69, v62, v60
    v_fma_f32 v77, v77, v62, v60
    v_fma_f32 v85, v85, v62, v60
    v_fma_f32 v93, v93, v62, v60
    v_mul_f32 v68, v68, v66
    v_mul_f32 v76, v76, v74
    v_mul_f32 v84, v84, v82
    v_mul_f32 v92, v92, v90
    v_mul_f32 v69, v69, v67
    v_mul_f32 v77, v77, v75
    v_mul_f32 v85, v85, v83
    v_mul_f32 v93, v93, v91
    v_exp_f32 v68, v68
    v_exp_f32 v76, v76
    v_exp_f32 v84, v84
    v_exp_f32 v92, v92
    v_exp_f32 v69, v69
    v_exp_f32 v77, v77
    v_exp_f32 v85, v85
    v_exp_f32 v93, v93
    v_lshlrev_b32 v70, 16, v72
    v_lshlrev_b32 v78, 16, v80
    v_lshlrev_b32 v86, 16, v88
    v_lshlrev_b32 v94, 16, v96
    v_and_b32 v71, 0xffff0000, v72
    v_and_b32 v79, 0xffff0000, v80
    v_and_b32 v87, 0xffff0000, v88
    v_and_b32 v95, 0xffff0000, v96
    v_add_f32 v68, 1.0, v68
    v_add_f32 v76, 1.0, v76
    v_add_f32 v84, 1.0, v84
    v_add_f32 v92, 1.0, v92
    v_add_f32 v69, 1.0, v69
    v_add_f32 v77, 1.0, v77
    v_add_f32 v85, 1.0, v85
    v_add_f32 v93, 1.0, v93
    v_rcp_f32 v68, v68
    v_rcp_f32 v76, v76
    v_rcp_f32 v84, v84
    v_rcp_f32 v92, v92
    v_rcp_f32 v69, v69
    v_rcp_f32 v77, v77
    v_rcp_f32 v85, v85
    v_rcp_f32 v93, v93
    v_mul_f32 v68, v68, v66
    v_mul_f32 v76, v76, v74
    v_mul_f32 v84, v84, v82
    v_mul_f32 v92, v92, v90
    v_mul_f32 v69, v69, v67
    v_mul_f32 v77, v77, v75
    v_mul_f32 v85, v85, v83
    v_mul_f32 v93, v93, v91
    v_cvt_pk_bf16_f32 v68, v68, v69
    v_cvt_pk_bf16_f32 v76, v76, v77
    v_cvt_pk_bf16_f32 v84, v84, v85
    v_cvt_pk_bf16_f32 v92, v92, v93
    v_lshlrev_b32 v66, 16, v68
    v_lshlrev_b32 v74, 16, v76
    v_lshlrev_b32 v82, 16, v84
    v_lshlrev_b32 v90, 16, v92
    v_and_b32 v67, 0xffff0000, v68
    v_and_b32 v75, 0xffff0000, v76
    v_and_b32 v83, 0xffff0000, v84
    v_and_b32 v91, 0xffff0000, v92
    v_mul_f32 v66, v66, v70
    v_mul_f32 v74, v74, v78
    v_mul_f32 v82, v82, v86
    v_mul_f32 v90, v90, v94
    v_mul_f32 v67, v67, v71
    v_mul_f32 v75, v75, v79
    v_mul_f32 v83, v83, v87
    v_mul_f32 v91, v91, v95
    v_cvt_pk_bf16_f32 v24, v66, v67
    v_cvt_pk_bf16_f32 v25, v74, v75
    v_cvt_pk_bf16_f32 v26, v82, v83
    v_cvt_pk_bf16_f32 v27, v90, v91
    buffer_store_dwordx4 v[24:27], v3, s[80:83], s28 offen offset:0
    v_cvt_pk_bf16_f32 v70, v152, v153
    v_cvt_pk_bf16_f32 v78, v154, v155
    v_cvt_pk_bf16_f32 v86, v156, v157
    v_cvt_pk_bf16_f32 v94, v158, v159
    v_cvt_pk_bf16_f32 v72, v216, v217
    v_cvt_pk_bf16_f32 v80, v218, v219
    v_cvt_pk_bf16_f32 v88, v220, v221
    v_cvt_pk_bf16_f32 v96, v222, v223
    v_lshlrev_b32 v66, 16, v70
    v_lshlrev_b32 v74, 16, v78
    v_lshlrev_b32 v82, 16, v86
    v_lshlrev_b32 v90, 16, v94
    v_and_b32 v67, 0xffff0000, v70
    v_and_b32 v75, 0xffff0000, v78
    v_and_b32 v83, 0xffff0000, v86
    v_and_b32 v91, 0xffff0000, v94
    v_mul_f32 v68, v66, v66
    v_mul_f32 v76, v74, v74
    v_mul_f32 v84, v82, v82
    v_mul_f32 v92, v90, v90
    v_mul_f32 v69, v67, v67
    v_mul_f32 v77, v75, v75
    v_mul_f32 v85, v83, v83
    v_mul_f32 v93, v91, v91
    v_fma_f32 v68, v68, v62, v60
    v_fma_f32 v76, v76, v62, v60
    v_fma_f32 v84, v84, v62, v60
    v_fma_f32 v92, v92, v62, v60
    v_fma_f32 v69, v69, v62, v60
    v_fma_f32 v77, v77, v62, v60
    v_fma_f32 v85, v85, v62, v60
    v_fma_f32 v93, v93, v62, v60
    v_mul_f32 v68, v68, v66
    v_mul_f32 v76, v76, v74
    v_mul_f32 v84, v84, v82
    v_mul_f32 v92, v92, v90
    v_mul_f32 v69, v69, v67
    v_mul_f32 v77, v77, v75
    v_mul_f32 v85, v85, v83
    v_mul_f32 v93, v93, v91
    v_exp_f32 v68, v68
    v_exp_f32 v76, v76
    v_exp_f32 v84, v84
    v_exp_f32 v92, v92
    v_exp_f32 v69, v69
    v_exp_f32 v77, v77
    v_exp_f32 v85, v85
    v_exp_f32 v93, v93
    v_lshlrev_b32 v70, 16, v72
    v_lshlrev_b32 v78, 16, v80
    v_lshlrev_b32 v86, 16, v88
    v_lshlrev_b32 v94, 16, v96
    v_and_b32 v71, 0xffff0000, v72
    v_and_b32 v79, 0xffff0000, v80
    v_and_b32 v87, 0xffff0000, v88
    v_and_b32 v95, 0xffff0000, v96
    v_add_f32 v68, 1.0, v68
    v_add_f32 v76, 1.0, v76
    v_add_f32 v84, 1.0, v84
    v_add_f32 v92, 1.0, v92
    v_add_f32 v69, 1.0, v69
    v_add_f32 v77, 1.0, v77
    v_add_f32 v85, 1.0, v85
    v_add_f32 v93, 1.0, v93
    v_rcp_f32 v68, v68
    v_rcp_f32 v76, v76
    v_rcp_f32 v84, v84
    v_rcp_f32 v92, v92
    v_rcp_f32 v69, v69
    v_rcp_f32 v77, v77
    v_rcp_f32 v85, v85
    v_rcp_f32 v93, v93
    v_mul_f32 v68, v68, v66
    v_mul_f32 v76, v76, v74
    v_mul_f32 v84, v84, v82
    v_mul_f32 v92, v92, v90
    v_mul_f32 v69, v69, v67
    v_mul_f32 v77, v77, v75
    v_mul_f32 v85, v85, v83
    v_mul_f32 v93, v93, v91
    v_cvt_pk_bf16_f32 v68, v68, v69
    v_cvt_pk_bf16_f32 v76, v76, v77
    v_cvt_pk_bf16_f32 v84, v84, v85
    v_cvt_pk_bf16_f32 v92, v92, v93
    v_lshlrev_b32 v66, 16, v68
    v_lshlrev_b32 v74, 16, v76
    v_lshlrev_b32 v82, 16, v84
    v_lshlrev_b32 v90, 16, v92
    v_and_b32 v67, 0xffff0000, v68
    v_and_b32 v75, 0xffff0000, v76
    v_and_b32 v83, 0xffff0000, v84
    v_and_b32 v91, 0xffff0000, v92
    v_mul_f32 v66, v66, v70
    v_mul_f32 v74, v74, v78
    v_mul_f32 v82, v82, v86
    v_mul_f32 v90, v90, v94
    v_mul_f32 v67, v67, v71
    v_mul_f32 v75, v75, v79
    v_mul_f32 v83, v83, v87
    v_mul_f32 v91, v91, v95
    v_cvt_pk_bf16_f32 v28, v66, v67
    v_cvt_pk_bf16_f32 v29, v74, v75
    v_cvt_pk_bf16_f32 v30, v82, v83
    v_cvt_pk_bf16_f32 v31, v90, v91
    buffer_store_dwordx4 v[28:31], v3, s[80:83], s28 offen offset:1024
    s_add_u32 s28, s28, 114688
    v_cvt_pk_bf16_f32 v70, v160, v161
    v_cvt_pk_bf16_f32 v78, v162, v163
    v_cvt_pk_bf16_f32 v86, v164, v165
    v_cvt_pk_bf16_f32 v94, v166, v167
    v_cvt_pk_bf16_f32 v72, v224, v225
    v_cvt_pk_bf16_f32 v80, v226, v227
    v_cvt_pk_bf16_f32 v88, v228, v229
    v_cvt_pk_bf16_f32 v96, v230, v231
    v_lshlrev_b32 v66, 16, v70
    v_lshlrev_b32 v74, 16, v78
    v_lshlrev_b32 v82, 16, v86
    v_lshlrev_b32 v90, 16, v94
    v_and_b32 v67, 0xffff0000, v70
    v_and_b32 v75, 0xffff0000, v78
    v_and_b32 v83, 0xffff0000, v86
    v_and_b32 v91, 0xffff0000, v94
    v_mul_f32 v68, v66, v66
    v_mul_f32 v76, v74, v74
    v_mul_f32 v84, v82, v82
    v_mul_f32 v92, v90, v90
    v_mul_f32 v69, v67, v67
    v_mul_f32 v77, v75, v75
    v_mul_f32 v85, v83, v83
    v_mul_f32 v93, v91, v91
    v_fma_f32 v68, v68, v62, v60
    v_fma_f32 v76, v76, v62, v60
    v_fma_f32 v84, v84, v62, v60
    v_fma_f32 v92, v92, v62, v60
    v_fma_f32 v69, v69, v62, v60
    v_fma_f32 v77, v77, v62, v60
    v_fma_f32 v85, v85, v62, v60
    v_fma_f32 v93, v93, v62, v60
    v_mul_f32 v68, v68, v66
    v_mul_f32 v76, v76, v74
    v_mul_f32 v84, v84, v82
    v_mul_f32 v92, v92, v90
    v_mul_f32 v69, v69, v67
    v_mul_f32 v77, v77, v75
    v_mul_f32 v85, v85, v83
    v_mul_f32 v93, v93, v91
    v_exp_f32 v68, v68
    v_exp_f32 v76, v76
    v_exp_f32 v84, v84
    v_exp_f32 v92, v92
    v_exp_f32 v69, v69
    v_exp_f32 v77, v77
    v_exp_f32 v85, v85
    v_exp_f32 v93, v93
    v_lshlrev_b32 v70, 16, v72
    v_lshlrev_b32 v78, 16, v80
    v_lshlrev_b32 v86, 16, v88
    v_lshlrev_b32 v94, 16, v96
    v_and_b32 v71, 0xffff0000, v72
    v_and_b32 v79, 0xffff0000, v80
    v_and_b32 v87, 0xffff0000, v88
    v_and_b32 v95, 0xffff0000, v96
    v_add_f32 v68, 1.0, v68
    v_add_f32 v76, 1.0, v76
    v_add_f32 v84, 1.0, v84
    v_add_f32 v92, 1.0, v92
    v_add_f32 v69, 1.0, v69
    v_add_f32 v77, 1.0, v77
    v_add_f32 v85, 1.0, v85
    v_add_f32 v93, 1.0, v93
    v_rcp_f32 v68, v68
    v_rcp_f32 v76, v76
    v_rcp_f32 v84, v84
    v_rcp_f32 v92, v92
    v_rcp_f32 v69, v69
    v_rcp_f32 v77, v77
    v_rcp_f32 v85, v85
    v_rcp_f32 v93, v93
    v_mul_f32 v68, v68, v66
    v_mul_f32 v76, v76, v74
    v_mul_f32 v84, v84, v82
    v_mul_f32 v92, v92, v90
    v_mul_f32 v69, v69, v67
    v_mul_f32 v77, v77, v75
    v_mul_f32 v85, v85, v83
    v_mul_f32 v93, v93, v91
    v_cvt_pk_bf16_f32 v68, v68, v69
    v_cvt_pk_bf16_f32 v76, v76, v77
    v_cvt_pk_bf16_f32 v84, v84, v85
    v_cvt_pk_bf16_f32 v92, v92, v93
    v_lshlrev_b32 v66, 16, v68
    v_lshlrev_b32 v74, 16, v76
    v_lshlrev_b32 v82, 16, v84
    v_lshlrev_b32 v90, 16, v92
    v_and_b32 v67, 0xffff0000, v68
    v_and_b32 v75, 0xffff0000, v76
    v_and_b32 v83, 0xffff0000, v84
    v_and_b32 v91, 0xffff0000, v92
    v_mul_f32 v66, v66, v70
    v_mul_f32 v74, v74, v78
    v_mul_f32 v82, v82, v86
    v_mul_f32 v90, v90, v94
    v_mul_f32 v67, v67, v71
    v_mul_f32 v75, v75, v79
    v_mul_f32 v83, v83, v87
    v_mul_f32 v91, v91, v95
    v_cvt_pk_bf16_f32 v16, v66, v67
    v_cvt_pk_bf16_f32 v17, v74, v75
    v_cvt_pk_bf16_f32 v18, v82, v83
    v_cvt_pk_bf16_f32 v19, v90, v91
    buffer_store_dwordx4 v[16:19], v3, s[80:83], s28 offen offset:0
    v_cvt_pk_bf16_f32 v70, v168, v169
    v_cvt_pk_bf16_f32 v78, v170, v171
    v_cvt_pk_bf16_f32 v86, v172, v173
    v_cvt_pk_bf16_f32 v94, v174, v175
    v_cvt_pk_bf16_f32 v72, v232, v233
    v_cvt_pk_bf16_f32 v80, v234, v235
    v_cvt_pk_bf16_f32 v88, v236, v237
    v_cvt_pk_bf16_f32 v96, v238, v239
    v_lshlrev_b32 v66, 16, v70
    v_lshlrev_b32 v74, 16, v78
    v_lshlrev_b32 v82, 16, v86
    v_lshlrev_b32 v90, 16, v94
    v_and_b32 v67, 0xffff0000, v70
    v_and_b32 v75, 0xffff0000, v78
    v_and_b32 v83, 0xffff0000, v86
    v_and_b32 v91, 0xffff0000, v94
    v_mul_f32 v68, v66, v66
    v_mul_f32 v76, v74, v74
    v_mul_f32 v84, v82, v82
    v_mul_f32 v92, v90, v90
    v_mul_f32 v69, v67, v67
    v_mul_f32 v77, v75, v75
    v_mul_f32 v85, v83, v83
    v_mul_f32 v93, v91, v91
    v_fma_f32 v68, v68, v62, v60
    v_fma_f32 v76, v76, v62, v60
    v_fma_f32 v84, v84, v62, v60
    v_fma_f32 v92, v92, v62, v60
    v_fma_f32 v69, v69, v62, v60
    v_fma_f32 v77, v77, v62, v60
    v_fma_f32 v85, v85, v62, v60
    v_fma_f32 v93, v93, v62, v60
    v_mul_f32 v68, v68, v66
    v_mul_f32 v76, v76, v74
    v_mul_f32 v84, v84, v82
    v_mul_f32 v92, v92, v90
    v_mul_f32 v69, v69, v67
    v_mul_f32 v77, v77, v75
    v_mul_f32 v85, v85, v83
    v_mul_f32 v93, v93, v91
    v_exp_f32 v68, v68
    v_exp_f32 v76, v76
    v_exp_f32 v84, v84
    v_exp_f32 v92, v92
    v_exp_f32 v69, v69
    v_exp_f32 v77, v77
    v_exp_f32 v85, v85
    v_exp_f32 v93, v93
    v_lshlrev_b32 v70, 16, v72
    v_lshlrev_b32 v78, 16, v80
    v_lshlrev_b32 v86, 16, v88
    v_lshlrev_b32 v94, 16, v96
    v_and_b32 v71, 0xffff0000, v72
    v_and_b32 v79, 0xffff0000, v80
    v_and_b32 v87, 0xffff0000, v88
    v_and_b32 v95, 0xffff0000, v96
    v_add_f32 v68, 1.0, v68
    v_add_f32 v76, 1.0, v76
    v_add_f32 v84, 1.0, v84
    v_add_f32 v92, 1.0, v92
    v_add_f32 v69, 1.0, v69
    v_add_f32 v77, 1.0, v77
    v_add_f32 v85, 1.0, v85
    v_add_f32 v93, 1.0, v93
    v_rcp_f32 v68, v68
    v_rcp_f32 v76, v76
    v_rcp_f32 v84, v84
    v_rcp_f32 v92, v92
    v_rcp_f32 v69, v69
    v_rcp_f32 v77, v77
    v_rcp_f32 v85, v85
    v_rcp_f32 v93, v93
    v_mul_f32 v68, v68, v66
    v_mul_f32 v76, v76, v74
    v_mul_f32 v84, v84, v82
    v_mul_f32 v92, v92, v90
    v_mul_f32 v69, v69, v67
    v_mul_f32 v77, v77, v75
    v_mul_f32 v85, v85, v83
    v_mul_f32 v93, v93, v91
    v_cvt_pk_bf16_f32 v68, v68, v69
    v_cvt_pk_bf16_f32 v76, v76, v77
    v_cvt_pk_bf16_f32 v84, v84, v85
    v_cvt_pk_bf16_f32 v92, v92, v93
    v_lshlrev_b32 v66, 16, v68
    v_lshlrev_b32 v74, 16, v76
    v_lshlrev_b32 v82, 16, v84
    v_lshlrev_b32 v90, 16, v92
    v_and_b32 v67, 0xffff0000, v68
    v_and_b32 v75, 0xffff0000, v76
    v_and_b32 v83, 0xffff0000, v84
    v_and_b32 v91, 0xffff0000, v92
    v_mul_f32 v66, v66, v70
    v_mul_f32 v74, v74, v78
    v_mul_f32 v82, v82, v86
    v_mul_f32 v90, v90, v94
    v_mul_f32 v67, v67, v71
    v_mul_f32 v75, v75, v79
    v_mul_f32 v83, v83, v87
    v_mul_f32 v91, v91, v95
    v_cvt_pk_bf16_f32 v20, v66, v67
    v_cvt_pk_bf16_f32 v21, v74, v75
    v_cvt_pk_bf16_f32 v22, v82, v83
    v_cvt_pk_bf16_f32 v23, v90, v91
    buffer_store_dwordx4 v[20:23], v3, s[80:83], s28 offen offset:1024
    s_add_u32 s28, s28, 114688
    v_cvt_pk_bf16_f32 v70, v176, v177
    v_cvt_pk_bf16_f32 v78, v178, v179
    v_cvt_pk_bf16_f32 v86, v180, v181
    v_cvt_pk_bf16_f32 v94, v182, v183
    v_cvt_pk_bf16_f32 v72, v240, v241
    v_cvt_pk_bf16_f32 v80, v242, v243
    v_cvt_pk_bf16_f32 v88, v244, v245
    v_cvt_pk_bf16_f32 v96, v246, v247
    v_lshlrev_b32 v66, 16, v70
    v_lshlrev_b32 v74, 16, v78
    v_lshlrev_b32 v82, 16, v86
    v_lshlrev_b32 v90, 16, v94
    v_and_b32 v67, 0xffff0000, v70
    v_and_b32 v75, 0xffff0000, v78
    v_and_b32 v83, 0xffff0000, v86
    v_and_b32 v91, 0xffff0000, v94
    v_mul_f32 v68, v66, v66
    v_mul_f32 v76, v74, v74
    v_mul_f32 v84, v82, v82
    v_mul_f32 v92, v90, v90
    v_mul_f32 v69, v67, v67
    v_mul_f32 v77, v75, v75
    v_mul_f32 v85, v83, v83
    v_mul_f32 v93, v91, v91
    v_fma_f32 v68, v68, v62, v60
    v_fma_f32 v76, v76, v62, v60
    v_fma_f32 v84, v84, v62, v60
    v_fma_f32 v92, v92, v62, v60
    v_fma_f32 v69, v69, v62, v60
    v_fma_f32 v77, v77, v62, v60
    v_fma_f32 v85, v85, v62, v60
    v_fma_f32 v93, v93, v62, v60
    v_mul_f32 v68, v68, v66
    v_mul_f32 v76, v76, v74
    v_mul_f32 v84, v84, v82
    v_mul_f32 v92, v92, v90
    v_mul_f32 v69, v69, v67
    v_mul_f32 v77, v77, v75
    v_mul_f32 v85, v85, v83
    v_mul_f32 v93, v93, v91
    v_exp_f32 v68, v68
    v_exp_f32 v76, v76
    v_exp_f32 v84, v84
    v_exp_f32 v92, v92
    v_exp_f32 v69, v69
    v_exp_f32 v77, v77
    v_exp_f32 v85, v85
    v_exp_f32 v93, v93
    v_lshlrev_b32 v70, 16, v72
    v_lshlrev_b32 v78, 16, v80
    v_lshlrev_b32 v86, 16, v88
    v_lshlrev_b32 v94, 16, v96
    v_and_b32 v71, 0xffff0000, v72
    v_and_b32 v79, 0xffff0000, v80
    v_and_b32 v87, 0xffff0000, v88
    v_and_b32 v95, 0xffff0000, v96
    v_add_f32 v68, 1.0, v68
    v_add_f32 v76, 1.0, v76
    v_add_f32 v84, 1.0, v84
    v_add_f32 v92, 1.0, v92
    v_add_f32 v69, 1.0, v69
    v_add_f32 v77, 1.0, v77
    v_add_f32 v85, 1.0, v85
    v_add_f32 v93, 1.0, v93
    v_rcp_f32 v68, v68
    v_rcp_f32 v76, v76
    v_rcp_f32 v84, v84
    v_rcp_f32 v92, v92
    v_rcp_f32 v69, v69
    v_rcp_f32 v77, v77
    v_rcp_f32 v85, v85
    v_rcp_f32 v93, v93
    v_mul_f32 v68, v68, v66
    v_mul_f32 v76, v76, v74
    v_mul_f32 v84, v84, v82
    v_mul_f32 v92, v92, v90
    v_mul_f32 v69, v69, v67
    v_mul_f32 v77, v77, v75
    v_mul_f32 v85, v85, v83
    v_mul_f32 v93, v93, v91
    v_cvt_pk_bf16_f32 v68, v68, v69
    v_cvt_pk_bf16_f32 v76, v76, v77
    v_cvt_pk_bf16_f32 v84, v84, v85
    v_cvt_pk_bf16_f32 v92, v92, v93
    v_lshlrev_b32 v66, 16, v68
    v_lshlrev_b32 v74, 16, v76
    v_lshlrev_b32 v82, 16, v84
    v_lshlrev_b32 v90, 16, v92
    v_and_b32 v67, 0xffff0000, v68
    v_and_b32 v75, 0xffff0000, v76
    v_and_b32 v83, 0xffff0000, v84
    v_and_b32 v91, 0xffff0000, v92
    v_mul_f32 v66, v66, v70
    v_mul_f32 v74, v74, v78
    v_mul_f32 v82, v82, v86
    v_mul_f32 v90, v90, v94
    v_mul_f32 v67, v67, v71
    v_mul_f32 v75, v75, v79
    v_mul_f32 v83, v83, v87
    v_mul_f32 v91, v91, v95
    v_cvt_pk_bf16_f32 v24, v66, v67
    v_cvt_pk_bf16_f32 v25, v74, v75
    v_cvt_pk_bf16_f32 v26, v82, v83
    v_cvt_pk_bf16_f32 v27, v90, v91
    buffer_store_dwordx4 v[24:27], v3, s[80:83], s28 offen offset:0
    v_cvt_pk_bf16_f32 v70, v184, v185
    v_cvt_pk_bf16_f32 v78, v186, v187
    v_cvt_pk_bf16_f32 v86, v188, v189
    v_cvt_pk_bf16_f32 v94, v190, v191
    v_cvt_pk_bf16_f32 v72, v248, v249
    v_cvt_pk_bf16_f32 v80, v250, v251
    v_cvt_pk_bf16_f32 v88, v252, v253
    v_cvt_pk_bf16_f32 v96, v254, v255
    v_lshlrev_b32 v66, 16, v70
    v_lshlrev_b32 v74, 16, v78
    v_lshlrev_b32 v82, 16, v86
    v_lshlrev_b32 v90, 16, v94
    v_and_b32 v67, 0xffff0000, v70
    v_and_b32 v75, 0xffff0000, v78
    v_and_b32 v83, 0xffff0000, v86
    v_and_b32 v91, 0xffff0000, v94
    v_mul_f32 v68, v66, v66
    v_mul_f32 v76, v74, v74
    v_mul_f32 v84, v82, v82
    v_mul_f32 v92, v90, v90
    v_mul_f32 v69, v67, v67
    v_mul_f32 v77, v75, v75
    v_mul_f32 v85, v83, v83
    v_mul_f32 v93, v91, v91
    v_fma_f32 v68, v68, v62, v60
    v_fma_f32 v76, v76, v62, v60
    v_fma_f32 v84, v84, v62, v60
    v_fma_f32 v92, v92, v62, v60
    v_fma_f32 v69, v69, v62, v60
    v_fma_f32 v77, v77, v62, v60
    v_fma_f32 v85, v85, v62, v60
    v_fma_f32 v93, v93, v62, v60
    v_mul_f32 v68, v68, v66
    v_mul_f32 v76, v76, v74
    v_mul_f32 v84, v84, v82
    v_mul_f32 v92, v92, v90
    v_mul_f32 v69, v69, v67
    v_mul_f32 v77, v77, v75
    v_mul_f32 v85, v85, v83
    v_mul_f32 v93, v93, v91
    v_exp_f32 v68, v68
    v_exp_f32 v76, v76
    v_exp_f32 v84, v84
    v_exp_f32 v92, v92
    v_exp_f32 v69, v69
    v_exp_f32 v77, v77
    v_exp_f32 v85, v85
    v_exp_f32 v93, v93
    v_lshlrev_b32 v70, 16, v72
    v_lshlrev_b32 v78, 16, v80
    v_lshlrev_b32 v86, 16, v88
    v_lshlrev_b32 v94, 16, v96
    v_and_b32 v71, 0xffff0000, v72
    v_and_b32 v79, 0xffff0000, v80
    v_and_b32 v87, 0xffff0000, v88
    v_and_b32 v95, 0xffff0000, v96
    v_add_f32 v68, 1.0, v68
    v_add_f32 v76, 1.0, v76
    v_add_f32 v84, 1.0, v84
    v_add_f32 v92, 1.0, v92
    v_add_f32 v69, 1.0, v69
    v_add_f32 v77, 1.0, v77
    v_add_f32 v85, 1.0, v85
    v_add_f32 v93, 1.0, v93
    v_rcp_f32 v68, v68
    v_rcp_f32 v76, v76
    v_rcp_f32 v84, v84
    v_rcp_f32 v92, v92
    v_rcp_f32 v69, v69
    v_rcp_f32 v77, v77
    v_rcp_f32 v85, v85
    v_rcp_f32 v93, v93
    v_mul_f32 v68, v68, v66
    v_mul_f32 v76, v76, v74
    v_mul_f32 v84, v84, v82
    v_mul_f32 v92, v92, v90
    v_mul_f32 v69, v69, v67
    v_mul_f32 v77, v77, v75
    v_mul_f32 v85, v85, v83
    v_mul_f32 v93, v93, v91
    v_cvt_pk_bf16_f32 v68, v68, v69
    v_cvt_pk_bf16_f32 v76, v76, v77
    v_cvt_pk_bf16_f32 v84, v84, v85
    v_cvt_pk_bf16_f32 v92, v92, v93
    v_lshlrev_b32 v66, 16, v68
    v_lshlrev_b32 v74, 16, v76
    v_lshlrev_b32 v82, 16, v84
    v_lshlrev_b32 v90, 16, v92
    v_and_b32 v67, 0xffff0000, v68
    v_and_b32 v75, 0xffff0000, v76
    v_and_b32 v83, 0xffff0000, v84
    v_and_b32 v91, 0xffff0000, v92
    v_mul_f32 v66, v66, v70
    v_mul_f32 v74, v74, v78
    v_mul_f32 v82, v82, v86
    v_mul_f32 v90, v90, v94
    v_mul_f32 v67, v67, v71
    v_mul_f32 v75, v75, v79
    v_mul_f32 v83, v83, v87
    v_mul_f32 v91, v91, v95
    v_cvt_pk_bf16_f32 v28, v66, v67
    v_cvt_pk_bf16_f32 v29, v74, v75
    v_cvt_pk_bf16_f32 v30, v82, v83
    v_cvt_pk_bf16_f32 v31, v90, v91
    buffer_store_dwordx4 v[28:31], v3, s[80:83], s28 offen offset:1024
    s_add_u32 s28, s28, 114688
    s_endpgm
k2_shd:
    s_load_dwordx2 s[4:5], s[0:1], 80
    s_sub_u32 s16, s2, 480
    s_lshl_b32 s16, s16, 2
    s_add_u32 s16, s16, s3
    s_lshr_b32 s17, s16, 4
    s_and_b32 s18, s16, 15
    v_lshrrev_b32 v5, 5, v2
    v_lshlrev_b32 v5, 12, v5
    v_and_b32 v4, 31, v2
    v_lshl_add_u32 v5, v4, 1, v5
    s_lshl_b32 s20, s18, 6
    v_add_u32 v5, s20, v5
    s_mul_i32 s20, s17, 229376
    s_mul_i32 s22, s18, 114688
    s_mul_i32 s21, s17, 14336
    s_add_u32 s22, s22, s21
    s_add_u32 s22, s22, 16777216
    s_waitcnt lgkmcnt(0)
    s_mov_b32 s84, s4
    s_and_b32 s85, s5, 0xffff
    s_mov_b32 s86, 1835008
    s_mov_b32 s87, 0x00020000
    s_add_u32 s21, s20, 0
    buffer_load_ushort v10, v5, s[84:87], s21 offen
    s_add_u32 s21, s20, 1024
    buffer_load_ushort v11, v5, s[84:87], s21 offen
    s_add_u32 s21, s20, 2048
    buffer_load_ushort v12, v5, s[84:87], s21 offen
    s_add_u32 s21, s20, 3072
    buffer_load_ushort v13, v5, s[84:87], s21 offen
    s_add_u32 s21, s20, 8192
    buffer_load_ushort v14, v5, s[84:87], s21 offen
    s_add_u32 s21, s20, 9216
    buffer_load_ushort v15, v5, s[84:87], s21 offen
    s_add_u32 s21, s20, 10240
    buffer_load_ushort v16, v5, s[84:87], s21 offen
    s_add_u32 s21, s20, 11264
    buffer_load_ushort v17, v5, s[84:87], s21 offen
    s_add_u32 s21, s20, 16384
    buffer_load_ushort v18, v5, s[84:87], s21 offen
    s_add_u32 s21, s20, 17408
    buffer_load_ushort v19, v5, s[84:87], s21 offen
    s_add_u32 s21, s20, 18432
    buffer_load_ushort v20, v5, s[84:87], s21 offen
    s_add_u32 s21, s20, 19456
    buffer_load_ushort v21, v5, s[84:87], s21 offen
    s_add_u32 s21, s20, 24576
    buffer_load_ushort v22, v5, s[84:87], s21 offen
    s_add_u32 s21, s20, 25600
    buffer_load_ushort v23, v5, s[84:87], s21 offen
    s_add_u32 s21, s20, 26624
    buffer_load_ushort v24, v5, s[84:87], s21 offen
    s_add_u32 s21, s20, 27648
    buffer_load_ushort v25, v5, s[84:87], s21 offen
    s_add_u32 s21, s20, 32768
    buffer_load_ushort v26, v5, s[84:87], s21 offen
    s_add_u32 s21, s20, 33792
    buffer_load_ushort v27, v5, s[84:87], s21 offen
    s_add_u32 s21, s20, 34816
    buffer_load_ushort v28, v5, s[84:87], s21 offen
    s_add_u32 s21, s20, 35840
    buffer_load_ushort v29, v5, s[84:87], s21 offen
    s_add_u32 s21, s20, 40960
    buffer_load_ushort v30, v5, s[84:87], s21 offen
    s_add_u32 s21, s20, 41984
    buffer_load_ushort v31, v5, s[84:87], s21 offen
    s_add_u32 s21, s20, 43008
    buffer_load_ushort v32, v5, s[84:87], s21 offen
    s_add_u32 s21, s20, 44032
    buffer_load_ushort v33, v5, s[84:87], s21 offen
    s_add_u32 s21, s20, 49152
    buffer_load_ushort v34, v5, s[84:87], s21 offen
    s_add_u32 s21, s20, 50176
    buffer_load_ushort v35, v5, s[84:87], s21 offen
    s_add_u32 s21, s20, 51200
    buffer_load_ushort v36, v5, s[84:87], s21 offen
    s_add_u32 s21, s20, 52224
    buffer_load_ushort v37, v5, s[84:87], s21 offen
    s_add_u32 s21, s20, 57344
    buffer_load_ushort v38, v5, s[84:87], s21 offen
    s_add_u32 s21, s20, 58368
    buffer_load_ushort v39, v5, s[84:87], s21 offen
    s_add_u32 s21, s20, 59392
    buffer_load_ushort v40, v5, s[84:87], s21 offen
    s_add_u32 s21, s20, 60416
    buffer_load_ushort v41, v5, s[84:87], s21 offen
    s_add_u32 s21, s20, 65536
    buffer_load_ushort v42, v5, s[84:87], s21 offen
    s_add_u32 s21, s20, 66560
    buffer_load_ushort v43, v5, s[84:87], s21 offen
    s_add_u32 s21, s20, 67584
    buffer_load_ushort v44, v5, s[84:87], s21 offen
    s_add_u32 s21, s20, 68608
    buffer_load_ushort v45, v5, s[84:87], s21 offen
    s_add_u32 s21, s20, 73728
    buffer_load_ushort v46, v5, s[84:87], s21 offen
    s_add_u32 s21, s20, 74752
    buffer_load_ushort v47, v5, s[84:87], s21 offen
    s_add_u32 s21, s20, 75776
    buffer_load_ushort v48, v5, s[84:87], s21 offen
    s_add_u32 s21, s20, 76800
    buffer_load_ushort v49, v5, s[84:87], s21 offen
    s_add_u32 s21, s20, 81920
    buffer_load_ushort v50, v5, s[84:87], s21 offen
    s_add_u32 s21, s20, 82944
    buffer_load_ushort v51, v5, s[84:87], s21 offen
    s_add_u32 s21, s20, 83968
    buffer_load_ushort v52, v5, s[84:87], s21 offen
    s_add_u32 s21, s20, 84992
    buffer_load_ushort v53, v5, s[84:87], s21 offen
    s_add_u32 s21, s20, 90112
    buffer_load_ushort v54, v5, s[84:87], s21 offen
    s_add_u32 s21, s20, 91136
    buffer_load_ushort v55, v5, s[84:87], s21 offen
    s_add_u32 s21, s20, 92160
    buffer_load_ushort v56, v5, s[84:87], s21 offen
    s_add_u32 s21, s20, 93184
    buffer_load_ushort v57, v5, s[84:87], s21 offen
    s_add_u32 s21, s20, 98304
    buffer_load_ushort v58, v5, s[84:87], s21 offen
    s_add_u32 s21, s20, 99328
    buffer_load_ushort v59, v5, s[84:87], s21 offen
    s_add_u32 s21, s20, 100352
    buffer_load_ushort v60, v5, s[84:87], s21 offen
    s_add_u32 s21, s20, 101376
    buffer_load_ushort v61, v5, s[84:87], s21 offen
    s_add_u32 s21, s20, 106496
    buffer_load_ushort v62, v5, s[84:87], s21 offen
    s_add_u32 s21, s20, 107520
    buffer_load_ushort v63, v5, s[84:87], s21 offen
    s_add_u32 s21, s20, 108544
    buffer_load_ushort v64, v5, s[84:87], s21 offen
    s_add_u32 s21, s20, 109568
    buffer_load_ushort v65, v5, s[84:87], s21 offen
    s_waitcnt vmcnt(48)
    v_lshl_or_b32 v70, v11, 16, v10
    v_lshl_or_b32 v71, v13, 16, v12
    v_lshl_or_b32 v72, v15, 16, v14
    v_lshl_or_b32 v73, v17, 16, v16
    s_add_u32 s21, s22, 0
    buffer_store_dwordx4 v[70:73], v3, s[80:83], s21 offen
    s_waitcnt vmcnt(41)
    v_lshl_or_b32 v74, v19, 16, v18
    v_lshl_or_b32 v75, v21, 16, v20
    v_lshl_or_b32 v76, v23, 16, v22
    v_lshl_or_b32 v77, v25, 16, v24
    s_add_u32 s21, s22, 1024
    buffer_store_dwordx4 v[74:77], v3, s[80:83], s21 offen
    s_waitcnt vmcnt(34)
    v_lshl_or_b32 v78, v27, 16, v26
    v_lshl_or_b32 v79, v29, 16, v28
    v_lshl_or_b32 v80, v31, 16, v30
    v_lshl_or_b32 v81, v33, 16, v32
    s_add_u32 s21, s22, 2048
    buffer_store_dwordx4 v[78:81], v3, s[80:83], s21 offen
    s_waitcnt vmcnt(27)
    v_lshl_or_b32 v82, v35, 16, v34
    v_lshl_or_b32 v83, v37, 16, v36
    v_lshl_or_b32 v84, v39, 16, v38
    v_lshl_or_b32 v85, v41, 16, v40
    s_add_u32 s21, s22, 3072
    buffer_store_dwordx4 v[82:85], v3, s[80:83], s21 offen
    s_waitcnt vmcnt(20)
    v_lshl_or_b32 v86, v43, 16, v42
    v_lshl_or_b32 v87, v45, 16, v44
    v_lshl_or_b32 v88, v47, 16, v46
    v_lshl_or_b32 v89, v49, 16, v48
    s_add_u32 s21, s22, 4096
    buffer_store_dwordx4 v[86:89], v3, s[80:83], s21 offen
    s_waitcnt vmcnt(13)
    v_lshl_or_b32 v90, v51, 16, v50
    v_lshl_or_b32 v91, v53, 16, v52
    v_lshl_or_b32 v92, v55, 16, v54
    v_lshl_or_b32 v93, v57, 16, v56
    s_add_u32 s21, s22, 5120
    buffer_store_dwordx4 v[90:93], v3, s[80:83], s21 offen
    s_waitcnt vmcnt(6)
    v_lshl_or_b32 v94, v59, 16, v58
    v_lshl_or_b32 v95, v61, 16, v60
    v_lshl_or_b32 v96, v63, 16, v62
    v_lshl_or_b32 v97, v65, 16, v64
    s_add_u32 s21, s22, 6144
    buffer_store_dwordx4 v[94:97], v3, s[80:83], s21 offen
    s_waitcnt vmcnt(0)
    s_add_u32 s21, s20, 114688
    buffer_load_ushort v10, v5, s[84:87], s21 offen
    s_add_u32 s21, s20, 115712
    buffer_load_ushort v11, v5, s[84:87], s21 offen
    s_add_u32 s21, s20, 116736
    buffer_load_ushort v12, v5, s[84:87], s21 offen
    s_add_u32 s21, s20, 117760
    buffer_load_ushort v13, v5, s[84:87], s21 offen
    s_add_u32 s21, s20, 122880
    buffer_load_ushort v14, v5, s[84:87], s21 offen
    s_add_u32 s21, s20, 123904
    buffer_load_ushort v15, v5, s[84:87], s21 offen
    s_add_u32 s21, s20, 124928
    buffer_load_ushort v16, v5, s[84:87], s21 offen
    s_add_u32 s21, s20, 125952
    buffer_load_ushort v17, v5, s[84:87], s21 offen
    s_add_u32 s21, s20, 131072
    buffer_load_ushort v18, v5, s[84:87], s21 offen
    s_add_u32 s21, s20, 132096
    buffer_load_ushort v19, v5, s[84:87], s21 offen
    s_add_u32 s21, s20, 133120
    buffer_load_ushort v20, v5, s[84:87], s21 offen
    s_add_u32 s21, s20, 134144
    buffer_load_ushort v21, v5, s[84:87], s21 offen
    s_add_u32 s21, s20, 139264
    buffer_load_ushort v22, v5, s[84:87], s21 offen
    s_add_u32 s21, s20, 140288
    buffer_load_ushort v23, v5, s[84:87], s21 offen
    s_add_u32 s21, s20, 141312
    buffer_load_ushort v24, v5, s[84:87], s21 offen
    s_add_u32 s21, s20, 142336
    buffer_load_ushort v25, v5, s[84:87], s21 offen
    s_add_u32 s21, s20, 147456
    buffer_load_ushort v26, v5, s[84:87], s21 offen
    s_add_u32 s21, s20, 148480
    buffer_load_ushort v27, v5, s[84:87], s21 offen
    s_add_u32 s21, s20, 149504
    buffer_load_ushort v28, v5, s[84:87], s21 offen
    s_add_u32 s21, s20, 150528
    buffer_load_ushort v29, v5, s[84:87], s21 offen
    s_add_u32 s21, s20, 155648
    buffer_load_ushort v30, v5, s[84:87], s21 offen
    s_add_u32 s21, s20, 156672
    buffer_load_ushort v31, v5, s[84:87], s21 offen
    s_add_u32 s21, s20, 157696
    buffer_load_ushort v32, v5, s[84:87], s21 offen
    s_add_u32 s21, s20, 158720
    buffer_load_ushort v33, v5, s[84:87], s21 offen
    s_add_u32 s21, s20, 163840
    buffer_load_ushort v34, v5, s[84:87], s21 offen
    s_add_u32 s21, s20, 164864
    buffer_load_ushort v35, v5, s[84:87], s21 offen
    s_add_u32 s21, s20, 165888
    buffer_load_ushort v36, v5, s[84:87], s21 offen
    s_add_u32 s21, s20, 166912
    buffer_load_ushort v37, v5, s[84:87], s21 offen
    s_add_u32 s21, s20, 172032
    buffer_load_ushort v38, v5, s[84:87], s21 offen
    s_add_u32 s21, s20, 173056
    buffer_load_ushort v39, v5, s[84:87], s21 offen
    s_add_u32 s21, s20, 174080
    buffer_load_ushort v40, v5, s[84:87], s21 offen
    s_add_u32 s21, s20, 175104
    buffer_load_ushort v41, v5, s[84:87], s21 offen
    s_add_u32 s21, s20, 180224
    buffer_load_ushort v42, v5, s[84:87], s21 offen
    s_add_u32 s21, s20, 181248
    buffer_load_ushort v43, v5, s[84:87], s21 offen
    s_add_u32 s21, s20, 182272
    buffer_load_ushort v44, v5, s[84:87], s21 offen
    s_add_u32 s21, s20, 183296
    buffer_load_ushort v45, v5, s[84:87], s21 offen
    s_add_u32 s21, s20, 188416
    buffer_load_ushort v46, v5, s[84:87], s21 offen
    s_add_u32 s21, s20, 189440
    buffer_load_ushort v47, v5, s[84:87], s21 offen
    s_add_u32 s21, s20, 190464
    buffer_load_ushort v48, v5, s[84:87], s21 offen
    s_add_u32 s21, s20, 191488
    buffer_load_ushort v49, v5, s[84:87], s21 offen
    s_add_u32 s21, s20, 196608
    buffer_load_ushort v50, v5, s[84:87], s21 offen
    s_add_u32 s21, s20, 197632
    buffer_load_ushort v51, v5, s[84:87], s21 offen
    s_add_u32 s21, s20, 198656
    buffer_load_ushort v52, v5, s[84:87], s21 offen
    s_add_u32 s21, s20, 199680
    buffer_load_ushort v53, v5, s[84:87], s21 offen
    s_add_u32 s21, s20, 204800
    buffer_load_ushort v54, v5, s[84:87], s21 offen
    s_add_u32 s21, s20, 205824
    buffer_load_ushort v55, v5, s[84:87], s21 offen
    s_add_u32 s21, s20, 206848
    buffer_load_ushort v56, v5, s[84:87], s21 offen
    s_add_u32 s21, s20, 207872
    buffer_load_ushort v57, v5, s[84:87], s21 offen
    s_add_u32 s21, s20, 212992
    buffer_load_ushort v58, v5, s[84:87], s21 offen
    s_add_u32 s21, s20, 214016
    buffer_load_ushort v59, v5, s[84:87], s21 offen
    s_add_u32 s21, s20, 215040
    buffer_load_ushort v60, v5, s[84:87], s21 offen
    s_add_u32 s21, s20, 216064
    buffer_load_ushort v61, v5, s[84:87], s21 offen
    s_add_u32 s21, s20, 221184
    buffer_load_ushort v62, v5, s[84:87], s21 offen
    s_add_u32 s21, s20, 222208
    buffer_load_ushort v63, v5, s[84:87], s21 offen
    s_add_u32 s21, s20, 223232
    buffer_load_ushort v64, v5, s[84:87], s21 offen
    s_add_u32 s21, s20, 224256
    buffer_load_ushort v65, v5, s[84:87], s21 offen
    s_waitcnt vmcnt(48)
    v_lshl_or_b32 v70, v11, 16, v10
    v_lshl_or_b32 v71, v13, 16, v12
    v_lshl_or_b32 v72, v15, 16, v14
    v_lshl_or_b32 v73, v17, 16, v16
    s_add_u32 s21, s22, 7168
    buffer_store_dwordx4 v[70:73], v3, s[80:83], s21 offen
    s_waitcnt vmcnt(41)
    v_lshl_or_b32 v74, v19, 16, v18
    v_lshl_or_b32 v75, v21, 16, v20
    v_lshl_or_b32 v76, v23, 16, v22
    v_lshl_or_b32 v77, v25, 16, v24
    s_add_u32 s21, s22, 8192
    buffer_store_dwordx4 v[74:77], v3, s[80:83], s21 offen
    s_waitcnt vmcnt(34)
    v_lshl_or_b32 v78, v27, 16, v26
    v_lshl_or_b32 v79, v29, 16, v28
    v_lshl_or_b32 v80, v31, 16, v30
    v_lshl_or_b32 v81, v33, 16, v32
    s_add_u32 s21, s22, 9216
    buffer_store_dwordx4 v[78:81], v3, s[80:83], s21 offen
    s_waitcnt vmcnt(27)
    v_lshl_or_b32 v82, v35, 16, v34
    v_lshl_or_b32 v83, v37, 16, v36
    v_lshl_or_b32 v84, v39, 16, v38
    v_lshl_or_b32 v85, v41, 16, v40
    s_add_u32 s21, s22, 10240
    buffer_store_dwordx4 v[82:85], v3, s[80:83], s21 offen
    s_waitcnt vmcnt(20)
    v_lshl_or_b32 v86, v43, 16, v42
    v_lshl_or_b32 v87, v45, 16, v44
    v_lshl_or_b32 v88, v47, 16, v46
    v_lshl_or_b32 v89, v49, 16, v48
    s_add_u32 s21, s22, 11264
    buffer_store_dwordx4 v[86:89], v3, s[80:83], s21 offen
    s_waitcnt vmcnt(13)
    v_lshl_or_b32 v90, v51, 16, v50
    v_lshl_or_b32 v91, v53, 16, v52
    v_lshl_or_b32 v92, v55, 16, v54
    v_lshl_or_b32 v93, v57, 16, v56
    s_add_u32 s21, s22, 12288
    buffer_store_dwordx4 v[90:93], v3, s[80:83], s21 offen
    s_waitcnt vmcnt(6)
    v_lshl_or_b32 v94, v59, 16, v58
    v_lshl_or_b32 v95, v61, 16, v60
    v_lshl_or_b32 v96, v63, 16, v62
    v_lshl_or_b32 v97, v65, 16, v64
    s_add_u32 s21, s22, 13312
    buffer_store_dwordx4 v[94:97], v3, s[80:83], s21 offen
k2_end:
    s_endpgm
.text
.globl k3_kernel
.p2align 8
.type k3_kernel,@function
k3_kernel:
    s_cmp_ge_u32 s2, 256
    s_cbranch_scc1 k3_end
    s_load_dwordx2 s[14:15], s[0:1], 104
    s_load_dwordx2 s[4:5], s[0:1], 0
    s_load_dwordx2 s[6:7], s[0:1], 48
    s_load_dwordx2 s[8:9], s[0:1], 88
    v_lshrrev_b32 v1, 6, v0
    v_and_b32 v2, 63, v0
    v_readfirstlane_b32 s3, v1
    v_lshlrev_b32 v3, 4, v2
    s_lshr_b32 s18, s2, 3
    s_and_b32 s16, s18, 7
    s_lshr_b32 s18, s18, 3
    s_and_b32 s17, s2, 7
    s_lshl_b32 s17, s17, 2
    s_add_u32 s17, s17, s18
    s_waitcnt lgkmcnt(0)
    s_mov_b32 s80, s14
    s_and_b32 s81, s15, 0xffff
    s_mov_b32 s82, 0x01b00000
    s_mov_b32 s83, 0x00020000
    s_and_b32 s19, s3, 1
    s_lshl_b32 s20, s16, 1
    s_add_u32 s20, s20, s19
    s_mul_i32 s20, s20, 114688
    s_add_u32 s20, s20, 16777216
    s_lshl_b32 s21, s17, 1
    s_add_u32 s21, s21, s19
    s_mul_i32 s21, s21, 114688
    s_add_u32 s21, s21, 18874368
    s_cmp_lt_u32 s3, 2
    s_cselect_b32 s20, s20, s21
    s_lshl_b32 s25, s3, 12
    s_add_u32 s26, s25, 0
    s_mov_b32 m0, s26
    s_nop 0
    buffer_load_dwordx4 v3, s[80:83], s20 offen lds
    buffer_load_dwordx4 v3, s[80:83], s20 offen offset:1024 lds
    buffer_load_dwordx4 v3, s[80:83], s20 offen offset:2048 lds
    buffer_load_dwordx4 v3, s[80:83], s20 offen offset:3072 lds
    s_add_u32 s20, s20, 4096
    s_add_u32 s26, s25, 16384
    s_mov_b32 m0, s26
    s_nop 0
    buffer_load_dwordx4 v3, s[80:83], s20 offen lds
    buffer_load_dwordx4 v3, s[80:83], s20 offen offset:1024 lds
    buffer_load_dwordx4 v3, s[80:83], s20 offen offset:2048 lds
    buffer_load_dwordx4 v3, s[80:83], s20 offen offset:3072 lds
    s_add_u32 s20, s20, 4096
    s_add_u32 s26, s25, 32768
    s_mov_b32 m0, s26
    s_nop 0
    buffer_load_dwordx4 v3, s[80:83], s20 offen lds
    buffer_load_dwordx4 v3, s[80:83], s20 offen offset:1024 lds
    buffer_load_dwordx4 v3, s[80:83], s20 offen offset:2048 lds
    buffer_load_dwordx4 v3, s[80:83], s20 offen offset:3072 lds
    s_add_u32 s20, s20, 4096
    s_add_u32 s26, s25, 49152
    s_mov_b32 m0, s26
    s_nop 0
    buffer_load_dwordx4 v3, s[80:83], s20 offen lds
    buffer_load_dwordx4 v3, s[80:83], s20 offen offset:1024 lds
    buffer_load_dwordx4 v3, s[80:83], s20 offen offset:2048 lds
    buffer_load_dwordx4 v3, s[80:83], s20 offen offset:3072 lds
    s_add_u32 s20, s20, 4096
    s_add_u32 s26, s25, 65536
    s_mov_b32 m0, s26
    s_nop 0
    buffer_load_dwordx4 v3, s[80:83], s20 offen lds
    buffer_load_dwordx4 v3, s[80:83], s20 offen offset:1024 lds
    buffer_load_dwordx4 v3, s[80:83], s20 offen offset:2048 lds
    buffer_load_dwordx4 v3, s[80:83], s20 offen offset:3072 lds
    s_add_u32 s20, s20, 4096
    s_add_u32 s26, s25, 81920
    s_mov_b32 m0, s26
    s_nop 0
    buffer_load_dwordx4 v3, s[80:83], s20 offen lds
    buffer_load_dwordx4 v3, s[80:83], s20 offen offset:1024 lds
    buffer_load_dwordx4 v3, s[80:83], s20 offen offset:2048 lds
    buffer_load_dwordx4 v3, s[80:83], s20 offen offset:3072 lds
    s_add_u32 s20, s20, 4096
    s_add_u32 s26, s25, 98304
    s_mov_b32 m0, s26
    s_nop 0
    buffer_load_dwordx4 v3, s[80:83], s20 offen lds
    buffer_load_dwordx4 v3, s[80:83], s20 offen offset:1024 lds
    buffer_load_dwordx4 v3, s[80:83], s20 offen offset:2048 lds
    buffer_load_dwordx4 v3, s[80:83], s20 offen offset:3072 lds
    s_add_u32 s20, s20, 4096
    s_mov_b32 s84, s4
    s_and_b32 s85, s5, 0xffff
    s_mov_b32 s86, 0x200000
    s_mov_b32 s87, 0x00020000
    s_mov_b32 s88, s6
    s_and_b32 s89, s7, 0xffff
    s_mov_b32 s90, 1024
    s_mov_b32 s91, 0x00020000
    s_mov_b32 s92, s8
    s_and_b32 s93, s9, 0xffff
    s_mov_b32 s94, 0x200000
    s_mov_b32 s95, 0x00020000
    s_lshr_b32 s24, s3, 1
    s_and_b32 s22, s3, 1
    s_lshl_b32 s26, s16, 1
    s_add_u32 s26, s26, s24
    s_lshl_b32 s27, s17, 1
    s_add_u32 s27, s27, s22
    v_and_b32 v4, 31, v2
    v_lshrrev_b32 v5, 5, v2
    v_lshlrev_b32 v6, 10, v4
    v_lshl_add_u32 v6, v5, 3, v6
    s_lshl_b32 s28, s27, 15
    s_lshl_b32 s29, s26, 6
    s_add_u32 s28, s28, s29
    v_lshlrev_b32 v7, 4, v4
    v_lshl_add_u32 v7, v5, 3, v7
    s_lshl_b32 s30, s27, 15
    s_lshl_b32 s31, s26, 11
    s_add_u32 s30, s30, s31
    s_add_u32 s30, s30, 0
    v_lshlrev_b32 v8, 3, v5
    v_lshlrev_b32 v9, 14, v5
    v_lshl_add_u32 v9, v4, 1, v9
    s_lshl_b32 s32, s26, 17
    s_lshl_b32 s33, s27, 6
    s_add_u32 s32, s32, s33
    s_add_u32 s32, s32, 26214400
    s_lshl_b32 s24, s24, 12
    s_lshl_b32 s22, s22, 12
    s_add_u32 s22, s22, 8192
    v_add_u32 v50, s24, v3
    v_add_u32 v51, s22, v3
    v_add_u32 v52, 65536, v50
    v_add_u32 v53, 65536, v51
    v_mov_b32 v96, 0
    v_mov_b32 v97, 0
    v_mov_b32 v98, 0
    v_mov_b32 v99, 0
    v_mov_b32 v100, 0
    v_mov_b32 v101, 0
    v_mov_b32 v102, 0
    v_mov_b32 v103, 0
    v_mov_b32 v104, 0
    v_mov_b32 v105, 0
    v_mov_b32 v106, 0
    v_mov_b32 v107, 0
    v_mov_b32 v108, 0
    v_mov_b32 v109, 0
    v_mov_b32 v110, 0
    v_mov_b32 v111, 0
    s_waitcnt vmcnt(24)
    s_barrier
    ds_read_b128 v[112:115], v50 offset:0
    ds_read_b128 v[116:119], v51 offset:0
    ds_read_b128 v[120:123], v50 offset:1024
    ds_read_b128 v[124:127], v51 offset:1024
    ds_read_b128 v[128:131], v50 offset:2048
    ds_read_b128 v[132:135], v51 offset:2048
    ds_read_b128 v[136:139], v50 offset:3072
    ds_read_b128 v[140:143], v51 offset:3072
    s_waitcnt vmcnt(20) lgkmcnt(0)
    s_barrier
    v_mfma_f32_32x32x16_bf16 v[96:111], v[112:115], v[116:119], v[96:111]
    ds_read_b128 v[144:147], v50 offset:16384
    ds_read_b128 v[148:151], v51 offset:16384
    ds_read_b128 v[152:155], v50 offset:17408
    ds_read_b128 v[156:159], v51 offset:17408
    v_mfma_f32_32x32x16_bf16 v[96:111], v[120:123], v[124:127], v[96:111]
    ds_read_b128 v[160:163], v50 offset:18432
    ds_read_b128 v[164:167], v51 offset:18432
    ds_read_b128 v[168:171], v50 offset:19456
    ds_read_b128 v[172:175], v51 offset:19456
    v_mfma_f32_32x32x16_bf16 v[96:111], v[128:131], v[132:135], v[96:111]
    s_add_u32 s26, s25, 114688
    s_mov_b32 m0, s26
    s_nop 0
    buffer_load_dwordx4 v3, s[80:83], s20 offen lds
    buffer_load_dwordx4 v3, s[80:83], s20 offen offset:1024 lds
    v_mfma_f32_32x32x16_bf16 v[96:111], v[136:139], v[140:143], v[96:111]
    buffer_load_dwordx4 v3, s[80:83], s20 offen offset:2048 lds
    buffer_load_dwordx4 v3, s[80:83], s20 offen offset:3072 lds
    s_add_u32 s20, s20, 4096
    s_waitcnt vmcnt(20) lgkmcnt(0)
    s_barrier
    v_mfma_f32_32x32x16_bf16 v[96:111], v[144:147], v[148:151], v[96:111]
    ds_read_b128 v[112:115], v50 offset:32768
    ds_read_b128 v[116:119], v51 offset:32768
    ds_read_b128 v[120:123], v50 offset:33792
    ds_read_b128 v[124:127], v51 offset:33792
    v_mfma_f32_32x32x16_bf16 v[96:111], v[152:155], v[156:159], v[96:111]
    ds_read_b128 v[128:131], v50 offset:34816
    ds_read_b128 v[132:135], v51 offset:34816
    ds_read_b128 v[136:139], v50 offset:35840
    ds_read_b128 v[140:143], v51 offset:35840
    v_mfma_f32_32x32x16_bf16 v[96:111], v[160:163], v[164:167], v[96:111]
    s_add_u32 s26, s25, 0
    s_mov_b32 m0, s26
    s_nop 0
    buffer_load_dwordx4 v3, s[80:83], s20 offen lds
    buffer_load_dwordx4 v3, s[80:83], s20 offen offset:1024 lds
    v_mfma_f32_32x32x16_bf16 v[96:111], v[168:171], v[172:175], v[96:111]
    buffer_load_dwordx4 v3, s[80:83], s20 offen offset:2048 lds
    buffer_load_dwordx4 v3, s[80:83], s20 offen offset:3072 lds
    s_add_u32 s20, s20, 4096
    s_waitcnt vmcnt(20) lgkmcnt(0)
    s_barrier
    v_mfma_f32_32x32x16_bf16 v[96:111], v[112:115], v[116:119], v[96:111]
    ds_read_b128 v[144:147], v50 offset:49152
    ds_read_b128 v[148:151], v51 offset:49152
    ds_read_b128 v[152:155], v50 offset:50176
    ds_read_b128 v[156:159], v51 offset:50176
    v_mfma_f32_32x32x16_bf16 v[96:111], v[120:123], v[124:127], v[96:111]
    ds_read_b128 v[160:163], v50 offset:51200
    ds_read_b128 v[164:167], v51 offset:51200
    ds_read_b128 v[168:171], v50 offset:52224
    ds_read_b128 v[172:175], v51 offset:52224
    v_mfma_f32_32x32x16_bf16 v[96:111], v[128:131], v[132:135], v[96:111]
    s_add_u32 s26, s25, 16384
    s_mov_b32 m0, s26
    s_nop 0
    buffer_load_dwordx4 v3, s[80:83], s20 offen lds
    buffer_load_dwordx4 v3, s[80:83], s20 offen offset:1024 lds
    v_mfma_f32_32x32x16_bf16 v[96:111], v[136:139], v[140:143], v[96:111]
    buffer_load_dwordx4 v3, s[80:83], s20 offen offset:2048 lds
    buffer_load_dwordx4 v3, s[80:83], s20 offen offset:3072 lds
    s_add_u32 s20, s20, 4096
    s_waitcnt vmcnt(20) lgkmcnt(0)
    s_barrier
    v_mfma_f32_32x32x16_bf16 v[96:111], v[144:147], v[148:151], v[96:111]
    ds_read_b128 v[112:115], v52 offset:0
    ds_read_b128 v[116:119], v53 offset:0
    ds_read_b128 v[120:123], v52 offset:1024
    ds_read_b128 v[124:127], v53 offset:1024
    v_mfma_f32_32x32x16_bf16 v[96:111], v[152:155], v[156:159], v[96:111]
    ds_read_b128 v[128:131], v52 offset:2048
    ds_read_b128 v[132:135], v53 offset:2048
    ds_read_b128 v[136:139], v52 offset:3072
    ds_read_b128 v[140:143], v53 offset:3072
    v_mfma_f32_32x32x16_bf16 v[96:111], v[160:163], v[164:167], v[96:111]
    s_add_u32 s26, s25, 32768
    s_mov_b32 m0, s26
    s_nop 0
    buffer_load_dwordx4 v3, s[80:83], s20 offen lds
    buffer_load_dwordx4 v3, s[80:83], s20 offen offset:1024 lds
    v_mfma_f32_32x32x16_bf16 v[96:111], v[168:171], v[172:175], v[96:111]
    buffer_load_dwordx4 v3, s[80:83], s20 offen offset:2048 lds
    buffer_load_dwordx4 v3, s[80:83], s20 offen offset:3072 lds
    s_add_u32 s20, s20, 4096
    s_waitcnt vmcnt(20) lgkmcnt(0)
    s_barrier
    v_mfma_f32_32x32x16_bf16 v[96:111], v[112:115], v[116:119], v[96:111]
    ds_read_b128 v[144:147], v52 offset:16384
    ds_read_b128 v[148:151], v53 offset:16384
    ds_read_b128 v[152:155], v52 offset:17408
    ds_read_b128 v[156:159], v53 offset:17408
    v_mfma_f32_32x32x16_bf16 v[96:111], v[120:123], v[124:127], v[96:111]
    ds_read_b128 v[160:163], v52 offset:18432
    ds_read_b128 v[164:167], v53 offset:18432
    ds_read_b128 v[168:171], v52 offset:19456
    ds_read_b128 v[172:175], v53 offset:19456
    v_mfma_f32_32x32x16_bf16 v[96:111], v[128:131], v[132:135], v[96:111]
    s_add_u32 s26, s25, 49152
    s_mov_b32 m0, s26
    s_nop 0
    buffer_load_dwordx4 v3, s[80:83], s20 offen lds
    buffer_load_dwordx4 v3, s[80:83], s20 offen offset:1024 lds
    v_mfma_f32_32x32x16_bf16 v[96:111], v[136:139], v[140:143], v[96:111]
    buffer_load_dwordx4 v3, s[80:83], s20 offen offset:2048 lds
    buffer_load_dwordx4 v3, s[80:83], s20 offen offset:3072 lds
    s_add_u32 s20, s20, 4096
    s_waitcnt vmcnt(20) lgkmcnt(0)
    s_barrier
    v_mfma_f32_32x32x16_bf16 v[96:111], v[144:147], v[148:151], v[96:111]
    ds_read_b128 v[112:115], v52 offset:32768
    ds_read_b128 v[116:119], v53 offset:32768
    ds_read_b128 v[120:123], v52 offset:33792
    ds_read_b128 v[124:127], v53 offset:33792
    v_mfma_f32_32x32x16_bf16 v[96:111], v[152:155], v[156:159], v[96:111]
    ds_read_b128 v[128:131], v52 offset:34816
    ds_read_b128 v[132:135], v53 offset:34816
    ds_read_b128 v[136:139], v52 offset:35840
    ds_read_b128 v[140:143], v53 offset:35840
    v_mfma_f32_32x32x16_bf16 v[96:111], v[160:163], v[164:167], v[96:111]
    s_add_u32 s26, s25, 65536
    s_mov_b32 m0, s26
    s_nop 0
    buffer_load_dwordx4 v3, s[80:83], s20 offen lds
    buffer_load_dwordx4 v3, s[80:83], s20 offen offset:1024 lds
    v_mfma_f32_32x32x16_bf16 v[96:111], v[168:171], v[172:175], v[96:111]
    buffer_load_dwordx4 v3, s[80:83], s20 offen offset:2048 lds
    buffer_load_dwordx4 v3, s[80:83], s20 offen offset:3072 lds
    s_add_u32 s20, s20, 4096
    s_waitcnt vmcnt(20) lgkmcnt(0)
    s_barrier
    v_mfma_f32_32x32x16_bf16 v[96:111], v[112:115], v[116:119], v[96:111]
    ds_read_b128 v[144:147], v52 offset:49152
    ds_read_b128 v[148:151], v53 offset:49152
    ds_read_b128 v[152:155], v52 offset:50176
    ds_read_b128 v[156:159], v53 offset:50176
    v_mfma_f32_32x32x16_bf16 v[96:111], v[120:123], v[124:127], v[96:111]
    ds_read_b128 v[160:163], v52 offset:51200
    ds_read_b128 v[164:167], v53 offset:51200
    ds_read_b128 v[168:171], v52 offset:52224
    ds_read_b128 v[172:175], v53 offset:52224
    v_mfma_f32_32x32x16_bf16 v[96:111], v[128:131], v[132:135], v[96:111]
    s_add_u32 s26, s25, 81920
    s_mov_b32 m0, s26
    s_nop 0
    buffer_load_dwordx4 v3, s[80:83], s20 offen lds
    buffer_load_dwordx4 v3, s[80:83], s20 offen offset:1024 lds
    v_mfma_f32_32x32x16_bf16 v[96:111], v[136:139], v[140:143], v[96:111]
    buffer_load_dwordx4 v3, s[80:83], s20 offen offset:2048 lds
    buffer_load_dwordx4 v3, s[80:83], s20 offen offset:3072 lds
    s_add_u32 s20, s20, 4096
    s_waitcnt vmcnt(20) lgkmcnt(0)
    s_barrier
    v_mfma_f32_32x32x16_bf16 v[96:111], v[144:147], v[148:151], v[96:111]
    ds_read_b128 v[112:115], v50 offset:0
    ds_read_b128 v[116:119], v51 offset:0
    ds_read_b128 v[120:123], v50 offset:1024
    ds_read_b128 v[124:127], v51 offset:1024
    v_mfma_f32_32x32x16_bf16 v[96:111], v[152:155], v[156:159], v[96:111]
    ds_read_b128 v[128:131], v50 offset:2048
    ds_read_b128 v[132:135], v51 offset:2048
    ds_read_b128 v[136:139], v50 offset:3072
    ds_read_b128 v[140:143], v51 offset:3072
    v_mfma_f32_32x32x16_bf16 v[96:111], v[160:163], v[164:167], v[96:111]
    s_add_u32 s26, s25, 98304
    s_mov_b32 m0, s26
    s_nop 0
    buffer_load_dwordx4 v3, s[80:83], s20 offen lds
    buffer_load_dwordx4 v3, s[80:83], s20 offen offset:1024 lds
    v_mfma_f32_32x32x16_bf16 v[96:111], v[168:171], v[172:175], v[96:111]
    buffer_load_dwordx4 v3, s[80:83], s20 offen offset:2048 lds
    buffer_load_dwordx4 v3, s[80:83], s20 offen offset:3072 lds
    s_add_u32 s20, s20, 4096
    s_waitcnt vmcnt(20) lgkmcnt(0)
    s_barrier
    v_mfma_f32_32x32x16_bf16 v[96:111], v[112:115], v[116:119], v[96:111]
    ds_read_b128 v[144:147], v50 offset:16384
    ds_read_b128 v[148:151], v51 offset:16384
    ds_read_b128 v[152:155], v50 offset:17408
    ds_read_b128 v[156:159], v51 offset:17408
    v_mfma_f32_32x32x16_bf16 v[96:111], v[120:123], v[124:127], v[96:111]
    ds_read_b128 v[160:163], v50 offset:18432
    ds_read_b128 v[164:167], v51 offset:18432
    ds_read_b128 v[168:171], v50 offset:19456
    ds_read_b128 v[172:175], v51 offset:19456
    v_mfma_f32_32x32x16_bf16 v[96:111], v[128:131], v[132:135], v[96:111]
    s_add_u32 s26, s25, 114688
    s_mov_b32 m0, s26
    s_nop 0
    buffer_load_dwordx4 v3, s[80:83], s20 offen lds
    buffer_load_dwordx4 v3, s[80:83], s20 offen offset:1024 lds
    v_mfma_f32_32x32x16_bf16 v[96:111], v[136:139], v[140:143], v[96:111]
    buffer_load_dwordx4 v3, s[80:83], s20 offen offset:2048 lds
    buffer_load_dwordx4 v3, s[80:83], s20 offen offset:3072 lds
    s_add_u32 s20, s20, 4096
    s_waitcnt vmcnt(20) lgkmcnt(0)
    s_barrier
    v_mfma_f32_32x32x16_bf16 v[96:111], v[144:147], v[148:151], v[96:111]
    ds_read_b128 v[112:115], v50 offset:32768
    ds_read_b128 v[116:119], v51 offset:32768
    ds_read_b128 v[120:123], v50 offset:33792
    ds_read_b128 v[124:127], v51 offset:33792
    v_mfma_f32_32x32x16_bf16 v[96:111], v[152:155], v[156:159], v[96:111]
    ds_read_b128 v[128:131], v50 offset:34816
    ds_read_b128 v[132:135], v51 offset:34816
    ds_read_b128 v[136:139], v50 offset:35840
    ds_read_b128 v[140:143], v51 offset:35840
    v_mfma_f32_32x32x16_bf16 v[96:111], v[160:163], v[164:167], v[96:111]
    s_add_u32 s26, s25, 0
    s_mov_b32 m0, s26
    s_nop 0
    buffer_load_dwordx4 v3, s[80:83], s20 offen lds
    buffer_load_dwordx4 v3, s[80:83], s20 offen offset:1024 lds
    v_mfma_f32_32x32x16_bf16 v[96:111], v[168:171], v[172:175], v[96:111]
    buffer_load_dwordx4 v3, s[80:83], s20 offen offset:2048 lds
    buffer_load_dwordx4 v3, s[80:83], s20 offen offset:3072 lds
    s_add_u32 s20, s20, 4096
    s_waitcnt vmcnt(20) lgkmcnt(0)
    s_barrier
    v_mfma_f32_32x32x16_bf16 v[96:111], v[112:115], v[116:119], v[96:111]
    ds_read_b128 v[144:147], v50 offset:49152
    ds_read_b128 v[148:151], v51 offset:49152
    ds_read_b128 v[152:155], v50 offset:50176
    ds_read_b128 v[156:159], v51 offset:50176
    v_mfma_f32_32x32x16_bf16 v[96:111], v[120:123], v[124:127], v[96:111]
    ds_read_b128 v[160:163], v50 offset:51200
    ds_read_b128 v[164:167], v51 offset:51200
    ds_read_b128 v[168:171], v50 offset:52224
    ds_read_b128 v[172:175], v51 offset:52224
    v_mfma_f32_32x32x16_bf16 v[96:111], v[128:131], v[132:135], v[96:111]
    s_add_u32 s26, s25, 16384
    s_mov_b32 m0, s26
    s_nop 0
    buffer_load_dwordx4 v3, s[80:83], s20 offen lds
    buffer_load_dwordx4 v3, s[80:83], s20 offen offset:1024 lds
    v_mfma_f32_32x32x16_bf16 v[96:111], v[136:139], v[140:143], v[96:111]
    buffer_load_dwordx4 v3, s[80:83], s20 offen offset:2048 lds
    buffer_load_dwordx4 v3, s[80:83], s20 offen offset:3072 lds
    s_add_u32 s20, s20, 4096
    s_waitcnt vmcnt(20) lgkmcnt(0)
    s_barrier
    v_mfma_f32_32x32x16_bf16 v[96:111], v[144:147], v[148:151], v[96:111]
    ds_read_b128 v[112:115], v52 offset:0
    ds_read_b128 v[116:119], v53 offset:0
    ds_read_b128 v[120:123], v52 offset:1024
    ds_read_b128 v[124:127], v53 offset:1024
    v_mfma_f32_32x32x16_bf16 v[96:111], v[152:155], v[156:159], v[96:111]
    ds_read_b128 v[128:131], v52 offset:2048
    ds_read_b128 v[132:135], v53 offset:2048
    ds_read_b128 v[136:139], v52 offset:3072
    ds_read_b128 v[140:143], v53 offset:3072
    v_mfma_f32_32x32x16_bf16 v[96:111], v[160:163], v[164:167], v[96:111]
    s_add_u32 s26, s25, 32768
    s_mov_b32 m0, s26
    s_nop 0
    buffer_load_dwordx4 v3, s[80:83], s20 offen lds
    buffer_load_dwordx4 v3, s[80:83], s20 offen offset:1024 lds
    v_mfma_f32_32x32x16_bf16 v[96:111], v[168:171], v[172:175], v[96:111]
    buffer_load_dwordx4 v3, s[80:83], s20 offen offset:2048 lds
    buffer_load_dwordx4 v3, s[80:83], s20 offen offset:3072 lds
    s_add_u32 s20, s20, 4096
    s_waitcnt vmcnt(20) lgkmcnt(0)
    s_barrier
    v_mfma_f32_32x32x16_bf16 v[96:111], v[112:115], v[116:119], v[96:111]
    ds_read_b128 v[144:147], v52 offset:16384
    ds_read_b128 v[148:151], v53 offset:16384
    ds_read_b128 v[152:155], v52 offset:17408
    ds_read_b128 v[156:159], v53 offset:17408
    v_mfma_f32_32x32x16_bf16 v[96:111], v[120:123], v[124:127], v[96:111]
    ds_read_b128 v[160:163], v52 offset:18432
    ds_read_b128 v[164:167], v53 offset:18432
    ds_read_b128 v[168:171], v52 offset:19456
    ds_read_b128 v[172:175], v53 offset:19456
    v_mfma_f32_32x32x16_bf16 v[96:111], v[128:131], v[132:135], v[96:111]
    s_add_u32 s26, s25, 49152
    s_mov_b32 m0, s26
    s_nop 0
    buffer_load_dwordx4 v3, s[80:83], s20 offen lds
    buffer_load_dwordx4 v3, s[80:83], s20 offen offset:1024 lds
    v_mfma_f32_32x32x16_bf16 v[96:111], v[136:139], v[140:143], v[96:111]
    buffer_load_dwordx4 v3, s[80:83], s20 offen offset:2048 lds
    buffer_load_dwordx4 v3, s[80:83], s20 offen offset:3072 lds
    s_add_u32 s20, s20, 4096
    s_waitcnt vmcnt(20) lgkmcnt(0)
    s_barrier
    v_mfma_f32_32x32x16_bf16 v[96:111], v[144:147], v[148:151], v[96:111]
    ds_read_b128 v[112:115], v52 offset:32768
    ds_read_b128 v[116:119], v53 offset:32768
    ds_read_b128 v[120:123], v52 offset:33792
    ds_read_b128 v[124:127], v53 offset:33792
    v_mfma_f32_32x32x16_bf16 v[96:111], v[152:155], v[156:159], v[96:111]
    ds_read_b128 v[128:131], v52 offset:34816
    ds_read_b128 v[132:135], v53 offset:34816
    ds_read_b128 v[136:139], v52 offset:35840
    ds_read_b128 v[140:143], v53 offset:35840
    v_mfma_f32_32x32x16_bf16 v[96:111], v[160:163], v[164:167], v[96:111]
    s_add_u32 s26, s25, 65536
    s_mov_b32 m0, s26
    s_nop 0
    buffer_load_dwordx4 v3, s[80:83], s20 offen lds
    buffer_load_dwordx4 v3, s[80:83], s20 offen offset:1024 lds
    v_mfma_f32_32x32x16_bf16 v[96:111], v[168:171], v[172:175], v[96:111]
    buffer_load_dwordx4 v3, s[80:83], s20 offen offset:2048 lds
    buffer_load_dwordx4 v3, s[80:83], s20 offen offset:3072 lds
    s_add_u32 s20, s20, 4096
    s_waitcnt vmcnt(20) lgkmcnt(0)
    s_barrier
    v_mfma_f32_32x32x16_bf16 v[96:111], v[112:115], v[116:119], v[96:111]
    ds_read_b128 v[144:147], v52 offset:49152
    ds_read_b128 v[148:151], v53 offset:49152
    ds_read_b128 v[152:155], v52 offset:50176
    ds_read_b128 v[156:159], v53 offset:50176
    v_mfma_f32_32x32x16_bf16 v[96:111], v[120:123], v[124:127], v[96:111]
    ds_read_b128 v[160:163], v52 offset:51200
    ds_read_b128 v[164:167], v53 offset:51200
    ds_read_b128 v[168:171], v52 offset:52224
    ds_read_b128 v[172:175], v53 offset:52224
    v_mfma_f32_32x32x16_bf16 v[96:111], v[128:131], v[132:135], v[96:111]
    s_add_u32 s26, s25, 81920
    s_mov_b32 m0, s26
    s_nop 0
    buffer_load_dwordx4 v3, s[80:83], s20 offen lds
    buffer_load_dwordx4 v3, s[80:83], s20 offen offset:1024 lds
    v_mfma_f32_32x32x16_bf16 v[96:111], v[136:139], v[140:143], v[96:111]
    buffer_load_dwordx4 v3, s[80:83], s20 offen offset:2048 lds
    buffer_load_dwordx4 v3, s[80:83], s20 offen offset:3072 lds
    s_add_u32 s20, s20, 4096
    s_waitcnt vmcnt(20) lgkmcnt(0)
    s_barrier
    v_mfma_f32_32x32x16_bf16 v[96:111], v[144:147], v[148:151], v[96:111]
    ds_read_b128 v[112:115], v50 offset:0
    ds_read_b128 v[116:119], v51 offset:0
    ds_read_b128 v[120:123], v50 offset:1024
    ds_read_b128 v[124:127], v51 offset:1024
    v_mfma_f32_32x32x16_bf16 v[96:111], v[152:155], v[156:159], v[96:111]
    ds_read_b128 v[128:131], v50 offset:2048
    ds_read_b128 v[132:135], v51 offset:2048
    ds_read_b128 v[136:139], v50 offset:3072
    ds_read_b128 v[140:143], v51 offset:3072
    v_mfma_f32_32x32x16_bf16 v[96:111], v[160:163], v[164:167], v[96:111]
    s_add_u32 s26, s25, 98304
    s_mov_b32 m0, s26
    s_nop 0
    buffer_load_dwordx4 v3, s[80:83], s20 offen lds
    buffer_load_dwordx4 v3, s[80:83], s20 offen offset:1024 lds
    v_mfma_f32_32x32x16_bf16 v[96:111], v[168:171], v[172:175], v[96:111]
    buffer_load_dwordx4 v3, s[80:83], s20 offen offset:2048 lds
    buffer_load_dwordx4 v3, s[80:83], s20 offen offset:3072 lds
    s_add_u32 s20, s20, 4096
    s_waitcnt vmcnt(20) lgkmcnt(0)
    s_barrier
    v_mfma_f32_32x32x16_bf16 v[96:111], v[112:115], v[116:119], v[96:111]
    ds_read_b128 v[144:147], v50 offset:16384
    ds_read_b128 v[148:151], v51 offset:16384
    ds_read_b128 v[152:155], v50 offset:17408
    ds_read_b128 v[156:159], v51 offset:17408
    v_mfma_f32_32x32x16_bf16 v[96:111], v[120:123], v[124:127], v[96:111]
    ds_read_b128 v[160:163], v50 offset:18432
    ds_read_b128 v[164:167], v51 offset:18432
    ds_read_b128 v[168:171], v50 offset:19456
    ds_read_b128 v[172:175], v51 offset:19456
    v_mfma_f32_32x32x16_bf16 v[96:111], v[128:131], v[132:135], v[96:111]
    s_add_u32 s26, s25, 114688
    s_mov_b32 m0, s26
    s_nop 0
    buffer_load_dwordx4 v3, s[80:83], s20 offen lds
    buffer_load_dwordx4 v3, s[80:83], s20 offen offset:1024 lds
    v_mfma_f32_32x32x16_bf16 v[96:111], v[136:139], v[140:143], v[96:111]
    buffer_load_dwordx4 v3, s[80:83], s20 offen offset:2048 lds
    buffer_load_dwordx4 v3, s[80:83], s20 offen offset:3072 lds
    s_add_u32 s20, s20, 4096
    s_waitcnt vmcnt(20) lgkmcnt(0)
    s_barrier
    v_mfma_f32_32x32x16_bf16 v[96:111], v[144:147], v[148:151], v[96:111]
    ds_read_b128 v[112:115], v50 offset:32768
    ds_read_b128 v[116:119], v51 offset:32768
    ds_read_b128 v[120:123], v50 offset:33792
    ds_read_b128 v[124:127], v51 offset:33792
    v_mfma_f32_32x32x16_bf16 v[96:111], v[152:155], v[156:159], v[96:111]
    ds_read_b128 v[128:131], v50 offset:34816
    ds_read_b128 v[132:135], v51 offset:34816
    ds_read_b128 v[136:139], v50 offset:35840
    ds_read_b128 v[140:143], v51 offset:35840
    v_mfma_f32_32x32x16_bf16 v[96:111], v[160:163], v[164:167], v[96:111]
    s_add_u32 s26, s25, 0
    s_mov_b32 m0, s26
    s_nop 0
    buffer_load_dwordx4 v3, s[80:83], s20 offen lds
    buffer_load_dwordx4 v3, s[80:83], s20 offen offset:1024 lds
    v_mfma_f32_32x32x16_bf16 v[96:111], v[168:171], v[172:175], v[96:111]
    buffer_load_dwordx4 v3, s[80:83], s20 offen offset:2048 lds
    buffer_load_dwordx4 v3, s[80:83], s20 offen offset:3072 lds
    s_add_u32 s20, s20, 4096
    s_waitcnt vmcnt(20) lgkmcnt(0)
    s_barrier
    v_mfma_f32_32x32x16_bf16 v[96:111], v[112:115], v[116:119], v[96:111]
    ds_read_b128 v[144:147], v50 offset:49152
    ds_read_b128 v[148:151], v51 offset:49152
    ds_read_b128 v[152:155], v50 offset:50176
    ds_read_b128 v[156:159], v51 offset:50176
    v_mfma_f32_32x32x16_bf16 v[96:111], v[120:123], v[124:127], v[96:111]
    ds_read_b128 v[160:163], v50 offset:51200
    ds_read_b128 v[164:167], v51 offset:51200
    ds_read_b128 v[168:171], v50 offset:52224
    ds_read_b128 v[172:175], v51 offset:52224
    v_mfma_f32_32x32x16_bf16 v[96:111], v[128:131], v[132:135], v[96:111]
    s_add_u32 s26, s25, 16384
    s_mov_b32 m0, s26
    s_nop 0
    buffer_load_dwordx4 v3, s[80:83], s20 offen lds
    buffer_load_dwordx4 v3, s[80:83], s20 offen offset:1024 lds
    v_mfma_f32_32x32x16_bf16 v[96:111], v[136:139], v[140:143], v[96:111]
    buffer_load_dwordx4 v3, s[80:83], s20 offen offset:2048 lds
    buffer_load_dwordx4 v3, s[80:83], s20 offen offset:3072 lds
    s_add_u32 s20, s20, 4096
    s_waitcnt vmcnt(20) lgkmcnt(0)
    s_barrier
    v_mfma_f32_32x32x16_bf16 v[96:111], v[144:147], v[148:151], v[96:111]
    ds_read_b128 v[112:115], v52 offset:0
    ds_read_b128 v[116:119], v53 offset:0
    ds_read_b128 v[120:123], v52 offset:1024
    ds_read_b128 v[124:127], v53 offset:1024
    v_mfma_f32_32x32x16_bf16 v[96:111], v[152:155], v[156:159], v[96:111]
    ds_read_b128 v[128:131], v52 offset:2048
    ds_read_b128 v[132:135], v53 offset:2048
    ds_read_b128 v[136:139], v52 offset:3072
    ds_read_b128 v[140:143], v53 offset:3072
    v_mfma_f32_32x32x16_bf16 v[96:111], v[160:163], v[164:167], v[96:111]
    s_add_u32 s26, s25, 32768
    s_mov_b32 m0, s26
    s_nop 0
    buffer_load_dwordx4 v3, s[80:83], s20 offen lds
    buffer_load_dwordx4 v3, s[80:83], s20 offen offset:1024 lds
    v_mfma_f32_32x32x16_bf16 v[96:111], v[168:171], v[172:175], v[96:111]
    buffer_load_dwordx4 v3, s[80:83], s20 offen offset:2048 lds
    buffer_load_dwordx4 v3, s[80:83], s20 offen offset:3072 lds
    s_add_u32 s20, s20, 4096
    s_waitcnt vmcnt(20) lgkmcnt(0)
    s_barrier
    v_mfma_f32_32x32x16_bf16 v[96:111], v[112:115], v[116:119], v[96:111]
    ds_read_b128 v[144:147], v52 offset:16384
    ds_read_b128 v[148:151], v53 offset:16384
    ds_read_b128 v[152:155], v52 offset:17408
    ds_read_b128 v[156:159], v53 offset:17408
    v_mfma_f32_32x32x16_bf16 v[96:111], v[120:123], v[124:127], v[96:111]
    ds_read_b128 v[160:163], v52 offset:18432
    ds_read_b128 v[164:167], v53 offset:18432
    ds_read_b128 v[168:171], v52 offset:19456
    ds_read_b128 v[172:175], v53 offset:19456
    v_mfma_f32_32x32x16_bf16 v[96:111], v[128:131], v[132:135], v[96:111]
    s_add_u32 s26, s25, 49152
    s_mov_b32 m0, s26
    s_nop 0
    buffer_load_dwordx4 v3, s[80:83], s20 offen lds
    buffer_load_dwordx4 v3, s[80:83], s20 offen offset:1024 lds
    v_mfma_f32_32x32x16_bf16 v[96:111], v[136:139], v[140:143], v[96:111]
    buffer_load_dwordx4 v3, s[80:83], s20 offen offset:2048 lds
    buffer_load_dwordx4 v3, s[80:83], s20 offen offset:3072 lds
    s_add_u32 s20, s20, 4096
    buffer_load_dwordx2 v[10:11], v6, s[84:87], s28 offen offset:0
    buffer_load_dwordx2 v[18:19], v7, s[80:83], s30 offen offset:0
    buffer_load_dwordx2 v[26:27], v8, s[88:91], s29 offen offset:0
    buffer_load_dwordx2 v[12:13], v6, s[84:87], s28 offen offset:16
    buffer_load_dwordx2 v[20:21], v7, s[80:83], s30 offen offset:512
    buffer_load_dwordx2 v[28:29], v8, s[88:91], s29 offen offset:16
    buffer_load_dwordx2 v[14:15], v6, s[84:87], s28 offen offset:32
    buffer_load_dwordx2 v[22:23], v7, s[80:83], s30 offen offset:1024
    buffer_load_dwordx2 v[30:31], v8, s[88:91], s29 offen offset:32
    buffer_load_dwordx2 v[16:17], v6, s[84:87], s28 offen offset:48
    buffer_load_dwordx2 v[24:25], v7, s[80:83], s30 offen offset:1536
    buffer_load_dwordx2 v[32:33], v8, s[88:91], s29 offen offset:48
    s_add_u32 s33, s32, 0
    buffer_load_ushort v34, v9, s[80:83], s33 offen
    s_add_u32 s33, s33, 4096
    buffer_load_ushort v35, v9, s[80:83], s33 offen
    s_add_u32 s33, s33, 4096
    buffer_load_ushort v36, v9, s[80:83], s33 offen
    s_add_u32 s33, s33, 4096
    buffer_load_ushort v37, v9, s[80:83], s33 offen
    s_add_u32 s33, s32, 32768
    buffer_load_ushort v38, v9, s[80:83], s33 offen
    s_add_u32 s33, s33, 4096
    buffer_load_ushort v39, v9, s[80:83], s33 offen
    s_add_u32 s33, s33, 4096
    buffer_load_ushort v40, v9, s[80:83], s33 offen
    s_add_u32 s33, s33, 4096
    buffer_load_ushort v41, v9, s[80:83], s33 offen
    s_add_u32 s33, s32, 65536
    buffer_load_ushort v42, v9, s[80:83], s33 offen
    s_add_u32 s33, s33, 4096
    buffer_load_ushort v43, v9, s[80:83], s33 offen
    s_add_u32 s33, s33, 4096
    buffer_load_ushort v44, v9, s[80:83], s33 offen
    s_add_u32 s33, s33, 4096
    buffer_load_ushort v45, v9, s[80:83], s33 offen
    s_add_u32 s33, s32, 98304
    buffer_load_ushort v46, v9, s[80:83], s33 offen
    s_add_u32 s33, s33, 4096
    buffer_load_ushort v47, v9, s[80:83], s33 offen
    s_add_u32 s33, s33, 4096
    buffer_load_ushort v48, v9, s[80:83], s33 offen
    s_add_u32 s33, s33, 4096
    buffer_load_ushort v49, v9, s[80:83], s33 offen
    s_waitcnt vmcnt(48) lgkmcnt(0)
    s_barrier
    v_mfma_f32_32x32x16_bf16 v[96:111], v[144:147], v[148:151], v[96:111]
    ds_read_b128 v[112:115], v52 offset:32768
    ds_read_b128 v[116:119], v53 offset:32768
    ds_read_b128 v[120:123], v52 offset:33792
    ds_read_b128 v[124:127], v53 offset:33792
    v_mfma_f32_32x32x16_bf16 v[96:111], v[152:155], v[156:159], v[96:111]
    ds_read_b128 v[128:131], v52 offset:34816
    ds_read_b128 v[132:135], v53 offset:34816
    ds_read_b128 v[136:139], v52 offset:35840
    ds_read_b128 v[140:143], v53 offset:35840
    v_mfma_f32_32x32x16_bf16 v[96:111], v[160:163], v[164:167], v[96:111]
    v_mfma_f32_32x32x16_bf16 v[96:111], v[168:171], v[172:175], v[96:111]
    s_waitcnt vmcnt(44) lgkmcnt(0)
    s_barrier
    v_mfma_f32_32x32x16_bf16 v[96:111], v[112:115], v[116:119], v[96:111]
    ds_read_b128 v[144:147], v52 offset:49152
    ds_read_b128 v[148:151], v53 offset:49152
    ds_read_b128 v[152:155], v52 offset:50176
    ds_read_b128 v[156:159], v53 offset:50176
    v_mfma_f32_32x32x16_bf16 v[96:111], v[120:123], v[124:127], v[96:111]
    ds_read_b128 v[160:163], v52 offset:51200
    ds_read_b128 v[164:167], v53 offset:51200
    ds_read_b128 v[168:171], v52 offset:52224
    ds_read_b128 v[172:175], v53 offset:52224
    v_mfma_f32_32x32x16_bf16 v[96:111], v[128:131], v[132:135], v[96:111]
    v_mfma_f32_32x32x16_bf16 v[96:111], v[136:139], v[140:143], v[96:111]
    s_waitcnt vmcnt(40) lgkmcnt(0)
    s_barrier
    v_mfma_f32_32x32x16_bf16 v[96:111], v[144:147], v[148:151], v[96:111]
    ds_read_b128 v[112:115], v50 offset:0
    ds_read_b128 v[116:119], v51 offset:0
    ds_read_b128 v[120:123], v50 offset:1024
    ds_read_b128 v[124:127], v51 offset:1024
    v_mfma_f32_32x32x16_bf16 v[96:111], v[152:155], v[156:159], v[96:111]
    ds_read_b128 v[128:131], v50 offset:2048
    ds_read_b128 v[132:135], v51 offset:2048
    ds_read_b128 v[136:139], v50 offset:3072
    ds_read_b128 v[140:143], v51 offset:3072
    v_mfma_f32_32x32x16_bf16 v[96:111], v[160:163], v[164:167], v[96:111]
    v_mfma_f32_32x32x16_bf16 v[96:111], v[168:171], v[172:175], v[96:111]
    s_waitcnt vmcnt(36) lgkmcnt(0)
    s_barrier
    v_mfma_f32_32x32x16_bf16 v[96:111], v[112:115], v[116:119], v[96:111]
    ds_read_b128 v[144:147], v50 offset:16384
    ds_read_b128 v[148:151], v51 offset:16384
    ds_read_b128 v[152:155], v50 offset:17408
    ds_read_b128 v[156:159], v51 offset:17408
    v_mfma_f32_32x32x16_bf16 v[96:111], v[120:123], v[124:127], v[96:111]
    ds_read_b128 v[160:163], v50 offset:18432
    ds_read_b128 v[164:167], v51 offset:18432
    ds_read_b128 v[168:171], v50 offset:19456
    ds_read_b128 v[172:175], v51 offset:19456
    v_mfma_f32_32x32x16_bf16 v[96:111], v[128:131], v[132:135], v[96:111]
    v_mfma_f32_32x32x16_bf16 v[96:111], v[136:139], v[140:143], v[96:111]
    s_waitcnt vmcnt(32) lgkmcnt(0)
    s_barrier
    v_mfma_f32_32x32x16_bf16 v[96:111], v[144:147], v[148:151], v[96:111]
    ds_read_b128 v[112:115], v50 offset:32768
    ds_read_b128 v[116:119], v51 offset:32768
    ds_read_b128 v[120:123], v50 offset:33792
    ds_read_b128 v[124:127], v51 offset:33792
    v_mfma_f32_32x32x16_bf16 v[96:111], v[152:155], v[156:159], v[96:111]
    ds_read_b128 v[128:131], v50 offset:34816
    ds_read_b128 v[132:135], v51 offset:34816
    ds_read_b128 v[136:139], v50 offset:35840
    ds_read_b128 v[140:143], v51 offset:35840
    v_mfma_f32_32x32x16_bf16 v[96:111], v[160:163], v[164:167], v[96:111]
    v_mfma_f32_32x32x16_bf16 v[96:111], v[168:171], v[172:175], v[96:111]
    s_waitcnt vmcnt(28) lgkmcnt(0)
    s_barrier
    v_mfma_f32_32x32x16_bf16 v[96:111], v[112:115], v[116:119], v[96:111]
    ds_read_b128 v[144:147], v50 offset:49152
    ds_read_b128 v[148:151], v51 offset:49152
    ds_read_b128 v[152:155], v50 offset:50176
    ds_read_b128 v[156:159], v51 offset:50176
    v_mfma_f32_32x32x16_bf16 v[96:111], v[120:123], v[124:127], v[96:111]
    ds_read_b128 v[160:163], v50 offset:51200
    ds_read_b128 v[164:167], v51 offset:51200
    ds_read_b128 v[168:171], v50 offset:52224
    ds_read_b128 v[172:175], v51 offset:52224
    v_mfma_f32_32x32x16_bf16 v[96:111], v[128:131], v[132:135], v[96:111]
    v_mfma_f32_32x32x16_bf16 v[96:111], v[136:139], v[140:143], v[96:111]
    s_waitcnt lgkmcnt(0)
    v_mfma_f32_32x32x16_bf16 v[96:111], v[144:147], v[148:151], v[96:111]
    v_mfma_f32_32x32x16_bf16 v[96:111], v[152:155], v[156:159], v[96:111]
    v_mfma_f32_32x32x16_bf16 v[96:111], v[160:163], v[164:167], v[96:111]
    v_mfma_f32_32x32x16_bf16 v[96:111], v[168:171], v[172:175], v[96:111]
    s_mov_b32 s34, 0xbfb8aa3b
    s_waitcnt vmcnt(0)
    s_nop 11
    v_cvt_pk_bf16_f32 v52, v96, v97
    v_lshlrev_b32 v53, 16, v52
    v_and_b32 v54, 0xffff0000, v52
    v_mul_f32 v55, s34, v53
    v_mul_f32 v56, s34, v54
    v_exp_f32 v55, v55
    v_exp_f32 v56, v56
    v_lshlrev_b32 v57, 16, v18
    v_and_b32 v58, 0xffff0000, v18
    v_lshlrev_b32 v59, 16, v26
    v_and_b32 v60, 0xffff0000, v26
    v_add_f32 v55, 1.0, v55
    v_add_f32 v56, 1.0, v56
    v_rcp_f32 v55, v55
    v_rcp_f32 v56, v56
    v_mul_f32 v57, v57, v59
    v_mul_f32 v58, v58, v60
    v_mul_f32 v55, v55, v53
    v_mul_f32 v56, v56, v54
    v_cvt_pk_bf16_f32 v57, v57, v58
    v_cvt_pk_bf16_f32 v55, v55, v56
    v_lshlrev_b32 v59, 16, v34
    v_lshlrev_b32 v60, 16, v35
    v_and_b32 v58, 0xffff0000, v57
    v_lshlrev_b32 v57, 16, v57
    v_add_f32 v57, v57, v59
    v_add_f32 v58, v58, v60
    v_cvt_pk_bf16_f32 v57, v57, v58
    v_and_b32 v56, 0xffff0000, v55
    v_lshlrev_b32 v55, 16, v55
    v_and_b32 v58, 0xffff0000, v57
    v_lshlrev_b32 v57, 16, v57
    v_mul_f32 v57, v57, v55
    v_mul_f32 v58, v58, v56
    v_cvt_pk_bf16_f32 v57, v57, v58
    v_lshlrev_b32 v59, 16, v10
    v_and_b32 v60, 0xffff0000, v10
    v_and_b32 v58, 0xffff0000, v57
    v_lshlrev_b32 v57, 16, v57
    v_add_f32 v57, v57, v59
    v_add_f32 v58, v58, v60
    v_cvt_pk_bf16_f32 v64, v57, v58
    v_cvt_pk_bf16_f32 v52, v98, v99
    v_lshlrev_b32 v53, 16, v52
    v_and_b32 v54, 0xffff0000, v52
    v_mul_f32 v55, s34, v53
    v_mul_f32 v56, s34, v54
    v_exp_f32 v55, v55
    v_exp_f32 v56, v56
    v_lshlrev_b32 v57, 16, v19
    v_and_b32 v58, 0xffff0000, v19
    v_lshlrev_b32 v59, 16, v27
    v_and_b32 v60, 0xffff0000, v27
    v_add_f32 v55, 1.0, v55
    v_add_f32 v56, 1.0, v56
    v_rcp_f32 v55, v55
    v_rcp_f32 v56, v56
    v_mul_f32 v57, v57, v59
    v_mul_f32 v58, v58, v60
    v_mul_f32 v55, v55, v53
    v_mul_f32 v56, v56, v54
    v_cvt_pk_bf16_f32 v57, v57, v58
    v_cvt_pk_bf16_f32 v55, v55, v56
    v_lshlrev_b32 v59, 16, v36
    v_lshlrev_b32 v60, 16, v37
    v_and_b32 v58, 0xffff0000, v57
    v_lshlrev_b32 v57, 16, v57
    v_add_f32 v57, v57, v59
    v_add_f32 v58, v58, v60
    v_cvt_pk_bf16_f32 v57, v57, v58
    v_and_b32 v56, 0xffff0000, v55
    v_lshlrev_b32 v55, 16, v55
    v_and_b32 v58, 0xffff0000, v57
    v_lshlrev_b32 v57, 16, v57
    v_mul_f32 v57, v57, v55
    v_mul_f32 v58, v58, v56
    v_cvt_pk_bf16_f32 v57, v57, v58
    v_lshlrev_b32 v59, 16, v11
    v_and_b32 v60, 0xffff0000, v11
    v_and_b32 v58, 0xffff0000, v57
    v_lshlrev_b32 v57, 16, v57
    v_add_f32 v57, v57, v59
    v_add_f32 v58, v58, v60
    v_cvt_pk_bf16_f32 v65, v57, v58
    buffer_store_dwordx2 v[64:65], v6, s[92:95], s28 offen offset:0
    v_cvt_pk_bf16_f32 v52, v100, v101
    v_lshlrev_b32 v53, 16, v52
    v_and_b32 v54, 0xffff0000, v52
    v_mul_f32 v55, s34, v53
    v_mul_f32 v56, s34, v54
    v_exp_f32 v55, v55
    v_exp_f32 v56, v56
    v_lshlrev_b32 v57, 16, v20
    v_and_b32 v58, 0xffff0000, v20
    v_lshlrev_b32 v59, 16, v28
    v_and_b32 v60, 0xffff0000, v28
    v_add_f32 v55, 1.0, v55
    v_add_f32 v56, 1.0, v56
    v_rcp_f32 v55, v55
    v_rcp_f32 v56, v56
    v_mul_f32 v57, v57, v59
    v_mul_f32 v58, v58, v60
    v_mul_f32 v55, v55, v53
    v_mul_f32 v56, v56, v54
    v_cvt_pk_bf16_f32 v57, v57, v58
    v_cvt_pk_bf16_f32 v55, v55, v56
    v_lshlrev_b32 v59, 16, v38
    v_lshlrev_b32 v60, 16, v39
    v_and_b32 v58, 0xffff0000, v57
    v_lshlrev_b32 v57, 16, v57
    v_add_f32 v57, v57, v59
    v_add_f32 v58, v58, v60
    v_cvt_pk_bf16_f32 v57, v57, v58
    v_and_b32 v56, 0xffff0000, v55
    v_lshlrev_b32 v55, 16, v55
    v_and_b32 v58, 0xffff0000, v57
    v_lshlrev_b32 v57, 16, v57
    v_mul_f32 v57, v57, v55
    v_mul_f32 v58, v58, v56
    v_cvt_pk_bf16_f32 v57, v57, v58
    v_lshlrev_b32 v59, 16, v12
    v_and_b32 v60, 0xffff0000, v12
    v_and_b32 v58, 0xffff0000, v57
    v_lshlrev_b32 v57, 16, v57
    v_add_f32 v57, v57, v59
    v_add_f32 v58, v58, v60
    v_cvt_pk_bf16_f32 v66, v57, v58
    v_cvt_pk_bf16_f32 v52, v102, v103
    v_lshlrev_b32 v53, 16, v52
    v_and_b32 v54, 0xffff0000, v52
    v_mul_f32 v55, s34, v53
    v_mul_f32 v56, s34, v54
    v_exp_f32 v55, v55
    v_exp_f32 v56, v56
    v_lshlrev_b32 v57, 16, v21
    v_and_b32 v58, 0xffff0000, v21
    v_lshlrev_b32 v59, 16, v29
    v_and_b32 v60, 0xffff0000, v29
    v_add_f32 v55, 1.0, v55
    v_add_f32 v56, 1.0, v56
    v_rcp_f32 v55, v55
    v_rcp_f32 v56, v56
    v_mul_f32 v57, v57, v59
    v_mul_f32 v58, v58, v60
    v_mul_f32 v55, v55, v53
    v_mul_f32 v56, v56, v54
    v_cvt_pk_bf16_f32 v57, v57, v58
    v_cvt_pk_bf16_f32 v55, v55, v56
    v_lshlrev_b32 v59, 16, v40
    v_lshlrev_b32 v60, 16, v41
    v_and_b32 v58, 0xffff0000, v57
    v_lshlrev_b32 v57, 16, v57
    v_add_f32 v57, v57, v59
    v_add_f32 v58, v58, v60
    v_cvt_pk_bf16_f32 v57, v57, v58
    v_and_b32 v56, 0xffff0000, v55
    v_lshlrev_b32 v55, 16, v55
    v_and_b32 v58, 0xffff0000, v57
    v_lshlrev_b32 v57, 16, v57
    v_mul_f32 v57, v57, v55
    v_mul_f32 v58, v58, v56
    v_cvt_pk_bf16_f32 v57, v57, v58
    v_lshlrev_b32 v59, 16, v13
    v_and_b32 v60, 0xffff0000, v13
    v_and_b32 v58, 0xffff0000, v57
    v_lshlrev_b32 v57, 16, v57
    v_add_f32 v57, v57, v59
    v_add_f32 v58, v58, v60
    v_cvt_pk_bf16_f32 v67, v57, v58
    buffer_store_dwordx2 v[66:67], v6, s[92:95], s28 offen offset:16
    v_cvt_pk_bf16_f32 v52, v104, v105
    v_lshlrev_b32 v53, 16, v52
    v_and_b32 v54, 0xffff0000, v52
    v_mul_f32 v55, s34, v53
    v_mul_f32 v56, s34, v54
    v_exp_f32 v55, v55
    v_exp_f32 v56, v56
    v_lshlrev_b32 v57, 16, v22
    v_and_b32 v58, 0xffff0000, v22
    v_lshlrev_b32 v59, 16, v30
    v_and_b32 v60, 0xffff0000, v30
    v_add_f32 v55, 1.0, v55
    v_add_f32 v56, 1.0, v56
    v_rcp_f32 v55, v55
    v_rcp_f32 v56, v56
    v_mul_f32 v57, v57, v59
    v_mul_f32 v58, v58, v60
    v_mul_f32 v55, v55, v53
    v_mul_f32 v56, v56, v54
    v_cvt_pk_bf16_f32 v57, v57, v58
    v_cvt_pk_bf16_f32 v55, v55, v56
    v_lshlrev_b32 v59, 16, v42
    v_lshlrev_b32 v60, 16, v43
    v_and_b32 v58, 0xffff0000, v57
    v_lshlrev_b32 v57, 16, v57
    v_add_f32 v57, v57, v59
    v_add_f32 v58, v58, v60
    v_cvt_pk_bf16_f32 v57, v57, v58
    v_and_b32 v56, 0xffff0000, v55
    v_lshlrev_b32 v55, 16, v55
    v_and_b32 v58, 0xffff0000, v57
    v_lshlrev_b32 v57, 16, v57
    v_mul_f32 v57, v57, v55
    v_mul_f32 v58, v58, v56
    v_cvt_pk_bf16_f32 v57, v57, v58
    v_lshlrev_b32 v59, 16, v14
    v_and_b32 v60, 0xffff0000, v14
    v_and_b32 v58, 0xffff0000, v57
    v_lshlrev_b32 v57, 16, v57
    v_add_f32 v57, v57, v59
    v_add_f32 v58, v58, v60
    v_cvt_pk_bf16_f32 v68, v57, v58
    v_cvt_pk_bf16_f32 v52, v106, v107
    v_lshlrev_b32 v53, 16, v52
    v_and_b32 v54, 0xffff0000, v52
    v_mul_f32 v55, s34, v53
    v_mul_f32 v56, s34, v54
    v_exp_f32 v55, v55
    v_exp_f32 v56, v56
    v_lshlrev_b32 v57, 16, v23
    v_and_b32 v58, 0xffff0000, v23
    v_lshlrev_b32 v59, 16, v31
    v_and_b32 v60, 0xffff0000, v31
    v_add_f32 v55, 1.0, v55
    v_add_f32 v56, 1.0, v56
    v_rcp_f32 v55, v55
    v_rcp_f32 v56, v56
    v_mul_f32 v57, v57, v59
    v_mul_f32 v58, v58, v60
    v_mul_f32 v55, v55, v53
    v_mul_f32 v56, v56, v54
    v_cvt_pk_bf16_f32 v57, v57, v58
    v_cvt_pk_bf16_f32 v55, v55, v56
    v_lshlrev_b32 v59, 16, v44
    v_lshlrev_b32 v60, 16, v45
    v_and_b32 v58, 0xffff0000, v57
    v_lshlrev_b32 v57, 16, v57
    v_add_f32 v57, v57, v59
    v_add_f32 v58, v58, v60
    v_cvt_pk_bf16_f32 v57, v57, v58
    v_and_b32 v56, 0xffff0000, v55
    v_lshlrev_b32 v55, 16, v55
    v_and_b32 v58, 0xffff0000, v57
    v_lshlrev_b32 v57, 16, v57
    v_mul_f32 v57, v57, v55
    v_mul_f32 v58, v58, v56
    v_cvt_pk_bf16_f32 v57, v57, v58
    v_lshlrev_b32 v59, 16, v15
    v_and_b32 v60, 0xffff0000, v15
    v_and_b32 v58, 0xffff0000, v57
    v_lshlrev_b32 v57, 16, v57
    v_add_f32 v57, v57, v59
    v_add_f32 v58, v58, v60
    v_cvt_pk_bf16_f32 v69, v57, v58
    buffer_store_dwordx2 v[68:69], v6, s[92:95], s28 offen offset:32
    v_cvt_pk_bf16_f32 v52, v108, v109
    v_lshlrev_b32 v53, 16, v52
    v_and_b32 v54, 0xffff0000, v52
    v_mul_f32 v55, s34, v53
    v_mul_f32 v56, s34, v54
    v_exp_f32 v55, v55
    v_exp_f32 v56, v56
    v_lshlrev_b32 v57, 16, v24
    v_and_b32 v58, 0xffff0000, v24
    v_lshlrev_b32 v59, 16, v32
    v_and_b32 v60, 0xffff0000, v32
    v_add_f32 v55, 1.0, v55
    v_add_f32 v56, 1.0, v56
    v_rcp_f32 v55, v55
    v_rcp_f32 v56, v56
    v_mul_f32 v57, v57, v59
    v_mul_f32 v58, v58, v60
    v_mul_f32 v55, v55, v53
    v_mul_f32 v56, v56, v54
    v_cvt_pk_bf16_f32 v57, v57, v58
    v_cvt_pk_bf16_f32 v55, v55, v56
    v_lshlrev_b32 v59, 16, v46
    v_lshlrev_b32 v60, 16, v47
    v_and_b32 v58, 0xffff0000, v57
    v_lshlrev_b32 v57, 16, v57
    v_add_f32 v57, v57, v59
    v_add_f32 v58, v58, v60
    v_cvt_pk_bf16_f32 v57, v57, v58
    v_and_b32 v56, 0xffff0000, v55
    v_lshlrev_b32 v55, 16, v55
    v_and_b32 v58, 0xffff0000, v57
    v_lshlrev_b32 v57, 16, v57
    v_mul_f32 v57, v57, v55
    v_mul_f32 v58, v58, v56
    v_cvt_pk_bf16_f32 v57, v57, v58
    v_lshlrev_b32 v59, 16, v16
    v_and_b32 v60, 0xffff0000, v16
    v_and_b32 v58, 0xffff0000, v57
    v_lshlrev_b32 v57, 16, v57
    v_add_f32 v57, v57, v59
    v_add_f32 v58, v58, v60
    v_cvt_pk_bf16_f32 v70, v57, v58
    v_cvt_pk_bf16_f32 v52, v110, v111
    v_lshlrev_b32 v53, 16, v52
    v_and_b32 v54, 0xffff0000, v52
    v_mul_f32 v55, s34, v53
    v_mul_f32 v56, s34, v54
    v_exp_f32 v55, v55
    v_exp_f32 v56, v56
    v_lshlrev_b32 v57, 16, v25
    v_and_b32 v58, 0xffff0000, v25
    v_lshlrev_b32 v59, 16, v33
    v_and_b32 v60, 0xffff0000, v33
    v_add_f32 v55, 1.0, v55
    v_add_f32 v56, 1.0, v56
    v_rcp_f32 v55, v55
    v_rcp_f32 v56, v56
    v_mul_f32 v57, v57, v59
    v_mul_f32 v58, v58, v60
    v_mul_f32 v55, v55, v53
    v_mul_f32 v56, v56, v54
    v_cvt_pk_bf16_f32 v57, v57, v58
    v_cvt_pk_bf16_f32 v55, v55, v56
    v_lshlrev_b32 v59, 16, v48
    v_lshlrev_b32 v60, 16, v49
    v_and_b32 v58, 0xffff0000, v57
    v_lshlrev_b32 v57, 16, v57
    v_add_f32 v57, v57, v59
    v_add_f32 v58, v58, v60
    v_cvt_pk_bf16_f32 v57, v57, v58
    v_and_b32 v56, 0xffff0000, v55
    v_lshlrev_b32 v55, 16, v55
    v_and_b32 v58, 0xffff0000, v57
    v_lshlrev_b32 v57, 16, v57
    v_mul_f32 v57, v57, v55
    v_mul_f32 v58, v58, v56
    v_cvt_pk_bf16_f32 v57, v57, v58
    v_lshlrev_b32 v59, 16, v17
    v_and_b32 v60, 0xffff0000, v17
    v_and_b32 v58, 0xffff0000, v57
    v_lshlrev_b32 v57, 16, v57
    v_add_f32 v57, v57, v59
    v_add_f32 v58, v58, v60
    v_cvt_pk_bf16_f32 v71, v57, v58
    buffer_store_dwordx2 v[70:71], v6, s[92:95], s28 offen offset:48
k3_end:
    s_endpgm
.section .rodata,"a"
.p2align 6
.amdhsa_kernel k1_kernel
  .amdhsa_next_free_vgpr 128
  .amdhsa_next_free_sgpr 102
  .amdhsa_accum_offset 128
  .amdhsa_group_segment_fixed_size 0
  .amdhsa_kernarg_size 112
  .amdhsa_user_sgpr_count 2
  .amdhsa_user_sgpr_kernarg_segment_ptr 1
  .amdhsa_system_sgpr_workgroup_id_x 1
.end_amdhsa_kernel
.p2align 6
.amdhsa_kernel k2_kernel
  .amdhsa_next_free_vgpr 256
  .amdhsa_next_free_sgpr 102
  .amdhsa_accum_offset 256
  .amdhsa_group_segment_fixed_size 0
  .amdhsa_kernarg_size 112
  .amdhsa_user_sgpr_count 2
  .amdhsa_user_sgpr_kernarg_segment_ptr 1
  .amdhsa_system_sgpr_workgroup_id_x 1
.end_amdhsa_kernel
.p2align 6
.amdhsa_kernel k3_kernel
  .amdhsa_next_free_vgpr 176
  .amdhsa_next_free_sgpr 102
  .amdhsa_accum_offset 176
  .amdhsa_group_segment_fixed_size 0
  .amdhsa_kernarg_size 112
  .amdhsa_user_sgpr_count 2
  .amdhsa_user_sgpr_kernarg_segment_ptr 1
  .amdhsa_system_sgpr_workgroup_id_x 1
.end_amdhsa_kernel
```
